```python
import torch

def _softmax(x, axis=-1):
    return torch.softmax(x, dim=axis)
def _gelu(x):
    return torch.nn.functional.gelu(x, approximate="tanh")
def _silu(x):
    return torch.nn.functional.silu(x)
def _sigmoid(x):
    return torch.sigmoid(x)
def _layernorm(x, axis=-1, eps=1e-5):
    m = x.mean(dim=axis, keepdim=True)
    v = x.var(dim=axis, keepdim=True, unbiased=False)
    return (x - m) / torch.sqrt(v + eps)
def _scatter_add(tgt, idx, src, axis=0):
    return tgt.clone().index_add_(axis, idx, src)
def _segment_sum(src, seg, n):
    out = torch.zeros((n,) + src.shape[1:], dtype=src.dtype)
    return out.index_add_(0, seg, src)
def _pad(x, pw):
    flat = tuple(v for pair in reversed(pw) for v in pair)
    return torch.nn.functional.pad(x, flat)

kernel_name = 'standalone__sequential_behavior_din__recsys'

def setup_inputs():

    _w = (lambda a: (lambda t: t.to(torch.bfloat16) if t.is_floating_point() else t)(torch.as_tensor(a)))
    B, L, D = 4096, 200, 128
    H = D
    return {
        "target": _w((lambda *s: torch.randn(*s, dtype=torch.bfloat16) * 1.6)(B, D)),
        "hist": _w((lambda *s: torch.randn(*s, dtype=torch.bfloat16) * 1.6)(B, L, D)),
        "mask": _w((lambda lo, hi, *s: torch.randint(lo, hi, s))(0, 2, B, L).to(float)),
        "w1": _w((lambda *s: torch.randn(*s, dtype=torch.bfloat16) * 1.6)(4 * D, H) * (4 * D) ** -0.5),
        "b1": _w((lambda *s: torch.randn(*s, dtype=torch.bfloat16) * 3.2)(H) * 0.1),
        "w2": _w((lambda *s: torch.randn(*s, dtype=torch.bfloat16) * 0.05)(H, 1) * H ** -0.5),
        "b2": _w((lambda *s: torch.randn(*s, dtype=torch.bfloat16) * 0.05)(1) * 0.1),
    }

def reference(target, hist, mask, w1, b1, w2, b2):
    L = hist.shape[1]
    tgt = (lambda x, n, axis: torch.repeat_interleave(x, n, dim=axis))(target[:, None, :], L, axis=1)
    feat = torch.concatenate([hist, tgt, hist - tgt, hist * tgt], axis=-1)
    h = _sigmoid(feat @ w1 + b1)
    scores = (h @ w2 + b2)[..., 0] * mask
    return torch.einsum('bl,bld->bd', scores, hist)
```

```asm
; @launch grid=(256,1,1) block=(512,1,1) lds=163840
.amdgcn_target "amdgcn-amd-amdhsa--gfx950"
.text
.globl standalone__sequential_behavior_din__recsys_kernel
.p2align 8
.type standalone__sequential_behavior_din__recsys_kernel,@function
standalone__sequential_behavior_din__recsys_kernel:
  s_cmp_ge_u32 s2, 256
  s_cbranch_scc1 L_end
  s_load_dwordx2 s[20:21], s[0:1], 16
  s_load_dwordx2 s[8:9], s[0:1], 24
  s_load_dwordx2 s[16:17], s[0:1], 0
  s_load_dwordx2 s[24:25], s[0:1], 32
  s_load_dwordx2 s[28:29], s[0:1], 40
  s_load_dwordx2 s[32:33], s[0:1], 48
  s_load_dwordx2 s[4:5], s[0:1], 8
  s_load_dwordx2 s[12:13], s[0:1], 56
  s_getpc_b64 s[50:51]
L_pc:
  s_mov_b32 s52, L_end-L_pc
  v_lshlrev_b32 v252, 6, v0
  v_add_u32 v252, 1536, v252
  v_min_u32 v252, s52, v252
  v_mov_b32 v253, s51
  v_add_co_u32 v252, vcc, s50, v252
  v_addc_co_u32 v253, vcc, 0, v253, vcc
  v_lshrrev_b32 v53, 6, v0
  v_and_b32 v48, 63, v0
  v_readfirstlane_b32 s50, v53
  v_and_b32 v0, 255, v0
  v_lshrrev_b32 v49, 5, v48
  v_and_b32 v50, 31, v48
  v_lshrrev_b32 v51, 4, v48
  v_and_b32 v52, 15, v48
  s_and_b32 s36, s50, 3
  s_lshr_b32 s38, s50, 2
  s_lshl_b32 s2, s2, 1
  s_add_u32 s2, s2, s38
  s_lshl_b32 s37, s36, 10
  s_lshl_b32 s50, s38, 16
  s_add_u32 s37, s37, s50
  s_lshl_b32 s45, s38, 14
  s_add_u32 s45, s45, 131072
  s_mov_b32 s48, 0xBFB8AA3B
  v_lshlrev_b32 v53, 3, v48
  s_mul_i32 s50, s36, 800
  v_add_u32 v53, s50, v53
  v_mov_b32 v54, 0x10000
  v_cmp_gt_u32 vcc, 50, v48
s_nop 1
  v_cndmask_b32 v53, v54, v53, vcc
  v_lshrrev_b32 v54, 3, v48
  s_lshl_b32 s50, s36, 3
  v_add_u32 v54, s50, v54
  v_and_b32 v56, 7, v48
  v_and_b32 v55, 2, v54
  v_lshlrev_b32 v55, 1, v55
  v_xor_b32 v55, v55, v56
  v_lshlrev_b32 v55, 4, v55
  v_lshl_add_u32 v24, v54, 8, v55
  s_mul_i32 s50, s2, 3200
  s_waitcnt lgkmcnt(0)
  s_add_u32 s20, s20, s50
  s_addc_u32 s21, s21, 0
  s_mov_b32 s22, 3200
  s_mov_b32 s23, 0x00020000
  buffer_load_dwordx2 v[80:81], v53, s[20:23], 0 offen
  buffer_load_dwordx2 v[82:83], v53, s[20:23], 0 offen offset:400
  s_cmp_lt_u32 s2, 32
  s_cselect_b64 exec, -1, 1
  global_load_dword v255, v[252:253], off
  s_mov_b64 exec, -1
  s_load_dword s49, s[32:33], 0
  s_mov_b32 s10, 131072
  s_mov_b32 s11, 0x00020000
  s_lshl_b32 s3, s38, 16
  s_lshl_b32 s50, s2, 11
  s_add_u32 s16, s16, s50
  s_addc_u32 s17, s17, 0
  s_mov_b32 s18, 2048
  s_mov_b32 s19, 0x00020000
  s_mov_b32 s26, 256
  s_mov_b32 s27, 0x00020000
  s_mov_b32 s30, 256
  s_mov_b32 s31, 0x00020000
  s_lshl_b32 s50, s36, 10
  s_add_u32 s50, s50, s45
  s_add_u32 m0, s50, 8000
  s_cmp_ge_u32 s36, 2
  s_cbranch_scc1 L_stg_bw
  s_lshl_b32 s50, s36, 2
  v_add_u32 v53, s50, v51
  v_xor_b32 v55, v53, v52
  v_lshlrev_b32 v55, 4, v55
  v_lshl_add_u32 v55, v53, 8, v55
  buffer_load_dwordx4 v55, s[16:19], 0 offen lds
  s_branch L_stg_done
L_stg_bw:
  v_lshlrev_b32 v55, 4, v48
  s_cmp_eq_u32 s36, 2
  s_cbranch_scc0 L_stg_w2
  buffer_load_dwordx4 v55, s[24:27], 0 offen lds
  s_branch L_stg_done
L_stg_w2:
  buffer_load_dwordx4 v55, s[28:31], 0 offen lds
L_stg_done:
  s_mul_i32 s50, s2, 409600
  s_add_u32 s4, s4, s50
  s_addc_u32 s5, s5, 0
  s_mov_b32 s6, 409600
  s_mov_b32 s7, 0x00020000
  s_lshl_b32 s50, s2, 11
  s_add_u32 s12, s12, s50
  s_addc_u32 s13, s13, 0
  s_mov_b32 s14, 256
  s_mov_b32 s15, 0x00020000
  v_lshlrev_b32 v53, 4, v0
  s_add_u32 s59, s45, 0
  v_add_u32 v53, s59, v53
  v_mov_b32 v54, 0
  v_cmp_gt_u32 vcc, 224, v0
  v_mov_b32 v100, 0
  v_mov_b32 v101, 0
  v_mov_b32 v102, 0
  v_mov_b32 v103, 0
  v_mov_b32 v55, -1
  v_cndmask_b32 v96, v54, v55, vcc
  v_mov_b32 v97, v96
  v_mov_b32 v98, v96
  v_mov_b32 v99, v96
  ds_write_b128 v53, v[96:99]
  v_add_u32 v55, 4096, v53
  s_add_u32 s50, s45, 7984
  v_min_u32 v55, s50, v55
  s_add_u32 s79, s3, 0
  s_add_u32 m0, s37, 0
s_nop 0
  buffer_load_dwordx4 v24, s[8:11], s79 offen lds
  ds_write_b128 v55, v[100:103]
  ds_write_b128 v53, v[100:103] offset:12096
  v_add_u32 v55, 16192, v53
  s_add_u32 s50, s45, 16304
  v_min_u32 v55, s50, v55
  ds_write_b128 v55, v[100:103]
  v_lshrrev_b32 v54, 3, v48
  s_lshl_b32 s50, s36, 3
  v_add_u32 v54, s50, v54
  v_lshrrev_b32 v55, 2, v54
  v_and_b32 v55, 4, v55
  v_lshrrev_b32 v56, 1, v54
  v_and_b32 v56, 3, v56
  v_or_b32 v55, v55, v56
  v_and_b32 v56, 7, v48
  v_xor_b32 v55, v55, v56
  v_lshlrev_b32 v10, 4, v55
  v_lshlrev_b32 v8, 1, v54
  s_add_u32 s59, s45, 0
  v_add_u32 v8, s59, v8
  v_and_b32 v60, 3, v52
  v_lshrrev_b32 v61, 1, v60
  s_and_b32 s50, s36, 1
  s_lshl_b32 s50, s50, 2
  v_or_b32 v61, s50, v61
  v_and_b32 v60, 1, v60
  v_lshlrev_b32 v60, 3, v60
  s_lshr_b32 s51, s36, 1
  s_lshl_b32 s51, s51, 12
  v_add_u32 v60, s51, v60
  v_and_b32 v57, 1, v51
  v_lshl_or_b32 v56, v57, 1, v61
  v_lshrrev_b32 v53, 2, v52
  v_lshl_add_u32 v54, v49, 3, v53
  v_and_b32 v58, 2, v53
  v_lshlrev_b32 v58, 1, v58
  v_xor_b32 v58, v58, v56
  v_lshl_add_u32 v58, v58, 4, v60
  v_add_u32 v57, 0, v54
  v_lshl_add_u32 v28, v57, 7, v58
  v_add_u32 v57, 4, v54
  v_lshl_add_u32 v29, v57, 7, v58
  v_add_u32 v57, 16, v54
  v_lshl_add_u32 v30, v57, 7, v58
  v_add_u32 v57, 20, v54
  v_lshl_add_u32 v31, v57, 7, v58
  v_lshrrev_b32 v53, 2, v50
  v_lshlrev_b32 v54, 8, v53
  s_add_u32 s59, s45, 8000
  v_add_u32 v64, s59, v54
  v_xor_b32 v65, v53, v49
  s_lshl_b32 s50, s36, 2
  v_lshrrev_b32 v53, 3, v50
  v_add_u32 v66, s50, v53
  v_and_b32 v53, 7, v50
  v_lshlrev_b32 v53, 1, v53
  s_add_u32 s59, s45, 8000
  v_add_u32 v67, s59, v53
  s_lshl_b32 s50, s36, 6
  v_lshlrev_b32 v53, 3, v49
  v_add_u32 v53, s50, v53
  s_add_u32 s59, s45, 10048
  v_add_u32 v180, s59, v53
  v_xor_b32 v53, v51, v52
  s_add_u32 m0, s37, 3968
s_nop 0
  buffer_load_dwordx4 v24, s[8:11], s79 offen offset:128 lds
  v_and_b32 v53, 1, v53
  v_lshlrev_b32 v53, 9, v53
  v_lshrrev_b32 v54, 1, v51
  v_lshl_add_u32 v53, v54, 3, v53
  v_add_u32 v53, s50, v53
  s_add_u32 s59, s45, 11072
  v_add_u32 v181, s59, v53
  v_xor_b32 v136, 0, v65
  v_lshl_add_u32 v136, v136, 4, v64
  v_xor_b32 v137, 2, v65
  v_lshl_add_u32 v137, v137, 4, v64
  v_xor_b32 v138, 4, v65
  v_lshl_add_u32 v138, v138, 4, v64
  v_xor_b32 v139, 6, v65
  v_lshl_add_u32 v139, v139, 4, v64
  v_xor_b32 v140, 8, v65
  v_lshl_add_u32 v140, v140, 4, v64
  v_xor_b32 v141, 10, v65
  v_lshl_add_u32 v141, v141, 4, v64
  v_xor_b32 v142, 12, v65
  v_lshl_add_u32 v142, v142, 4, v64
  v_xor_b32 v143, 14, v65
  v_lshl_add_u32 v143, v143, 4, v64
  v_xor_b32 v128, 0, v66
  v_lshl_add_u32 v128, v128, 4, v67
  v_xor_b32 v129, 1, v66
  v_lshl_add_u32 v129, v129, 4, v67
  v_xor_b32 v130, 2, v66
  v_lshl_add_u32 v130, v130, 4, v67
  v_xor_b32 v131, 3, v66
  v_lshl_add_u32 v131, v131, 4, v67
  v_xor_b32 v132, 4, v66
  v_lshl_add_u32 v132, v132, 4, v67
  v_xor_b32 v133, 5, v66
  v_lshl_add_u32 v133, v133, 4, v67
  v_xor_b32 v134, 6, v66
  v_lshl_add_u32 v134, v134, 4, v67
  v_xor_b32 v135, 7, v66
  v_lshl_add_u32 v135, v135, 4, v67
  v_add_u32 v188, 0x10000, v28
  v_add_u32 v189, 0x10000, v29
  v_add_u32 v190, 0x10000, v30
  v_add_u32 v191, 0x10000, v31
  s_lshl_b32 s58, s38, 16
  v_lshrrev_b32 v53, 2, v50
  v_and_b32 v53, 4, v53
  v_lshrrev_b32 v54, 1, v50
  v_and_b32 v54, 3, v54
  v_or_b32 v53, v53, v54
  v_xor_b32 v53, v53, v49
  v_lshlrev_b32 v54, 7, v50
  v_add_u32 v54, s58, v54
  v_xor_b32 v55, 0, v53
  v_lshl_add_u32 v0, v55, 4, v54
  v_xor_b32 v55, 2, v53
  v_lshl_add_u32 v1, v55, 4, v54
  v_xor_b32 v55, 4, v53
  v_lshl_add_u32 v2, v55, 4, v54
  v_xor_b32 v55, 6, v53
  v_lshl_add_u32 v3, v55, 4, v54
  s_lshl_b32 s58, s38, 16
  v_lshrrev_b32 v53, 2, v52
  v_and_b32 v54, 1, v53
  s_add_u32 s79, s3, 8192
  s_add_u32 m0, s37, 8192
s_nop 0
  buffer_load_dwordx4 v24, s[8:11], s79 offen lds
  v_lshlrev_b32 v54, 4, v54
  v_lshrrev_b32 v53, 1, v53
  v_add_u32 v54, v53, v54
  v_lshl_add_u32 v54, v51, 2, v54
  v_add_u32 v55, s58, v60
  v_add_u32 v57, 0, v54
  v_lshrrev_b32 v58, 2, v57
  v_and_b32 v58, 4, v58
  v_lshrrev_b32 v59, 1, v57
  v_and_b32 v59, 3, v59
  v_or_b32 v58, v58, v59
  v_xor_b32 v58, v58, v61
  v_lshl_add_u32 v57, v57, 7, v55
  v_xor_b32 v59, 0, v58
  v_lshl_add_u32 v4, v59, 4, v57
  v_xor_b32 v59, 2, v58
  v_lshl_add_u32 v5, v59, 4, v57
  v_add_u32 v57, 2, v54
  v_lshrrev_b32 v58, 2, v57
  v_and_b32 v58, 4, v58
  v_lshrrev_b32 v59, 1, v57
  v_and_b32 v59, 3, v59
  v_or_b32 v58, v58, v59
  v_xor_b32 v58, v58, v61
  v_lshl_add_u32 v57, v57, 7, v55
  v_xor_b32 v59, 0, v58
  v_lshl_add_u32 v6, v59, 4, v57
  v_xor_b32 v59, 2, v58
  v_lshl_add_u32 v7, v59, 4, v57
  s_lshl_b32 s50, s36, 6
  v_lshlrev_b32 v53, 2, v52
  v_add_u32 v53, s50, v53
  s_add_u32 s59, s45, 7232
  v_add_u32 v14, s59, v53
  v_and_b32 v53, 3, v52
  v_lshlrev_b32 v53, 6, v53
  v_lshl_add_u32 v53, v51, 4, v53
  s_add_u32 s59, s45, 7232
  v_add_u32 v15, s59, v53
  v_lshlrev_b32 v53, 1, v52
  s_add_u32 s59, s45, 3584
  v_add_u32 v11, s59, v53
  s_lshl_b32 s50, s36, 7
  v_lshlrev_b32 v53, 4, v49
  v_add_u32 v53, s50, v53
  s_add_u32 s59, s45, 8000
  v_add_u32 v19, s59, v53
  v_lshrrev_b32 v53, 2, v50
  v_lshl_add_u32 v21, v53, 9, v19
  s_lshl_b32 s50, s36, 6
  v_lshlrev_b32 v53, 1, v48
  v_add_u32 v53, s50, v53
  v_mov_b32 v54, 0x40000000
  v_cmp_gt_u32 vcc, 32, v48
s_nop 1
  v_cndmask_b32 v20, v54, v53, vcc
  v_and_b32 v53, 0x13, v50
  v_lshrrev_b32 v54, 1, v50
  v_and_b32 v54, 4, v54
  v_or_b32 v53, v53, v54
  v_lshlrev_b32 v54, 1, v50
  v_and_b32 v54, 8, v54
  v_or_b32 v53, v53, v54
  v_lshrrev_b32 v54, 2, v50
  s_add_u32 m0, s37, 12160
s_nop 0
  buffer_load_dwordx4 v24, s[8:11], s79 offen offset:128 lds
  v_and_b32 v54, 1, v54
  v_xor_b32 v54, v54, v49
  v_lshrrev_b32 v55, 4, v50
  v_lshl_or_b32 v55, v54, 1, v55
  v_lshlrev_b32 v56, 4, v53
  v_mov_b32 v57, 512
  v_cmp_eq_u32 vcc, 0, v55
s_nop 1
  v_cndmask_b32 v58, v57, v56, vcc
  s_add_u32 s59, s45, 12096
  v_add_u32 v16, s59, v58
  v_cmp_eq_u32 vcc, 1, v55
s_nop 1
  v_cndmask_b32 v58, v57, v56, vcc
  s_add_u32 s59, s45, 12096
  v_add_u32 v17, s59, v58
  v_and_b32 v56, 7, v53
  v_lshrrev_b32 v56, 1, v56
  v_lshl_add_u32 v56, v55, 2, v56
  v_and_b32 v57, 1, v50
  v_lshlrev_b32 v57, 4, v57
  v_mov_b32 v58, 0x3F80
  v_lshlrev_b32 v57, v57, v58
  v_mov_b32 v58, 0
  v_cmp_eq_u32 vcc, 0, v56
s_nop 1
  v_cndmask_b32 v32, v58, v57, vcc
  v_cmp_eq_u32 vcc, 1, v56
s_nop 1
  v_cndmask_b32 v33, v58, v57, vcc
  v_cmp_eq_u32 vcc, 2, v56
s_nop 1
  v_cndmask_b32 v34, v58, v57, vcc
  v_cmp_eq_u32 vcc, 3, v56
s_nop 1
  v_cndmask_b32 v35, v58, v57, vcc
  v_cmp_eq_u32 vcc, 4, v56
s_nop 1
  v_cndmask_b32 v36, v58, v57, vcc
  v_cmp_eq_u32 vcc, 5, v56
s_nop 1
  v_cndmask_b32 v37, v58, v57, vcc
  v_cmp_eq_u32 vcc, 6, v56
s_nop 1
  v_cndmask_b32 v38, v58, v57, vcc
  v_cmp_eq_u32 vcc, 7, v56
s_nop 1
  v_cndmask_b32 v39, v58, v57, vcc
  s_mul_i32 s50, s36, 528
  v_and_b32 v53, 7, v50
  v_lshlrev_b32 v53, 1, v53
  v_lshl_add_u32 v53, v50, 4, v53
  v_add_u32 v53, s50, v53
  s_add_u32 s59, s45, 12096
  v_add_u32 v18, s59, v53
  s_mov_b32 s46, 0xFFFF0000
  s_mov_b32 s47, 0xFFFF0000
  s_waitcnt vmcnt(6)
  v_and_b32 v53, 0x7fff, v80
  v_cmp_ne_u32 s[80:81], 0, v53
  v_and_b32 v53, 0x7fff0000, v80
  v_cmp_ne_u32 s[82:83], 0, v53
  v_and_b32 v53, 0x7fff, v81
  s_add_u32 s79, s3, 16384
  s_add_u32 m0, s37, 16384
s_nop 0
  buffer_load_dwordx4 v24, s[8:11], s79 offen lds
  v_cmp_ne_u32 s[84:85], 0, v53
  v_and_b32 v53, 0x7fff0000, v81
  v_cmp_ne_u32 s[86:87], 0, v53
  v_and_b32 v53, 0x7fff, v82
  v_cmp_ne_u32 s[88:89], 0, v53
  v_and_b32 v53, 0x7fff0000, v82
  v_cmp_ne_u32 s[90:91], 0, v53
  v_and_b32 v53, 0x7fff, v83
  v_cmp_ne_u32 s[92:93], 0, v53
  v_and_b32 v53, 0x7fff0000, v83
  v_cmp_ne_u32 s[94:95], 0, v53
  v_mbcnt_lo_u32_b32 v84, s80, 0
  v_mbcnt_hi_u32_b32 v84, s81, v84
  s_bcnt1_i32_b64 s50, s[80:81]
  v_mbcnt_lo_u32_b32 v85, s82, 0
  v_mbcnt_hi_u32_b32 v85, s83, v85
  s_add_u32 m0, s37, 20352
s_nop 0
  buffer_load_dwordx4 v24, s[8:11], s79 offen offset:128 lds
  s_bcnt1_i32_b64 s51, s[82:83]
  v_mbcnt_lo_u32_b32 v86, s84, 0
  v_mbcnt_hi_u32_b32 v86, s85, v86
  s_bcnt1_i32_b64 s52, s[84:85]
  v_mbcnt_lo_u32_b32 v87, s86, 0
  v_mbcnt_hi_u32_b32 v87, s87, v87
  s_bcnt1_i32_b64 s53, s[86:87]
  v_mbcnt_lo_u32_b32 v88, s88, 0
  v_mbcnt_hi_u32_b32 v88, s89, v88
  s_bcnt1_i32_b64 s54, s[88:89]
  v_mbcnt_lo_u32_b32 v89, s90, 0
  v_mbcnt_hi_u32_b32 v89, s91, v89
  s_bcnt1_i32_b64 s55, s[90:91]
  v_mbcnt_lo_u32_b32 v90, s92, 0
  v_mbcnt_hi_u32_b32 v90, s93, v90
  s_bcnt1_i32_b64 s56, s[92:93]
  v_mbcnt_lo_u32_b32 v91, s94, 0
  s_add_u32 s79, s3, 24576
  s_add_u32 m0, s37, 24576
s_nop 0
  buffer_load_dwordx4 v24, s[8:11], s79 offen lds
  v_mbcnt_hi_u32_b32 v91, s95, v91
  s_bcnt1_i32_b64 s57, s[94:95]
  s_add_u32 s60, s50, s51
  s_add_u32 s61, s60, s52
  s_add_u32 s58, s61, s53
  s_mov_b32 s51, s50
  s_mov_b32 s50, 0
  s_mov_b32 s52, s60
  s_mov_b32 s53, s61
  s_add_u32 s62, s58, 31
  s_lshr_b32 s62, s62, 5
  s_max_u32 s62, s62, 1
  s_add_u32 s60, s54, s55
  s_add_u32 s61, s60, s56
  s_add_u32 s59, s61, s57
  s_mov_b32 s55, s54
  s_mov_b32 s54, 0
  s_add_u32 m0, s37, 28544
s_nop 0
  buffer_load_dwordx4 v24, s[8:11], s79 offen offset:128 lds
  s_mov_b32 s56, s60
  s_mov_b32 s57, s61
  s_add_u32 s63, s59, 31
  s_lshr_b32 s63, s63, 5
  s_max_u32 s63, s63, 1
  s_lshl_b32 s64, s36, 3
  s_add_u32 s64, s64, 16320
  s_add_u32 s64, s64, s45
  v_mov_b32 v53, s64
  v_mov_b32 v58, s62
  v_mov_b32 v59, s63
  ds_write_b64 v53, v[58:59]
  s_waitcnt lgkmcnt(0)
  s_barrier
  s_add_u32 s64, s45, 16320
  v_mov_b32 v53, s64
  ds_read_b128 v[104:107], v53
  ds_read_b128 v[108:111], v53 offset:16
  s_mov_b32 s44, 2112
  s_add_u32 s79, s3, 32768
  s_add_u32 m0, s37, 32768
s_nop 0
  buffer_load_dwordx4 v24, s[8:11], s79 offen lds
  v_lshlrev_b32 v54, 2, v48
  s_mul_i32 s66, s36, 400
  v_add_u32 v54, s66, v54
  s_waitcnt lgkmcnt(0)
  v_readfirstlane_b32 s71, v104
  v_readfirstlane_b32 s72, v105
  v_readfirstlane_b32 s73, v106
  v_readfirstlane_b32 s74, v107
  v_readfirstlane_b32 s75, v108
  v_readfirstlane_b32 s76, v109
  v_readfirstlane_b32 s77, v110
  v_readfirstlane_b32 s78, v111
  s_mov_b32 s70, 0
  s_add_u32 s71, s71, s70
  s_add_u32 s72, s72, s71
  s_add_u32 s73, s73, s72
  s_add_u32 s74, s74, s73
  s_add_u32 m0, s37, 36736
s_nop 0
  buffer_load_dwordx4 v24, s[8:11], s79 offen offset:128 lds
  s_add_u32 s75, s75, s74
  s_add_u32 s76, s76, s75
  s_add_u32 s77, s77, s76
  s_add_u32 s78, s78, s77
  s_lshl_b32 m0, s36, 1
s_nop 0
  s_movrels_b32 s64, s70
  s_movrels_b32 s65, s71
  s_lshl_b32 s64, s64, 6
  s_add_u32 s64, s64, s45
  s_lshl_b32 s66, s50, 1
  s_add_u32 s66, s66, s64
  v_lshl_add_u32 v55, v84, 1, s66
  v_add_u32 v56, 0, v54
  s_mov_b64 exec, s[80:81]
  ds_write_b16 v55, v56 offset:0
  ds_write_b16 v55, v80 offset:3648
  s_mov_b64 exec, -1
  s_lshl_b32 s66, s51, 1
  s_add_u32 s79, s3, 40960
  s_add_u32 m0, s37, 40960
s_nop 0
  buffer_load_dwordx4 v24, s[8:11], s79 offen lds
  s_add_u32 s66, s66, s64
  v_lshl_add_u32 v57, v85, 1, s66
  v_add_u32 v59, 1, v54
  s_mov_b64 exec, s[82:83]
  ds_write_b16 v57, v59 offset:0
  ds_write_b16_d16_hi v57, v80 offset:3648
  s_mov_b64 exec, -1
  s_lshl_b32 s66, s52, 1
  s_add_u32 s66, s66, s64
  v_lshl_add_u32 v55, v86, 1, s66
  v_add_u32 v56, 2, v54
  s_mov_b64 exec, s[84:85]
  ds_write_b16 v55, v56 offset:0
  ds_write_b16 v55, v81 offset:3648
  s_mov_b64 exec, -1
  s_lshl_b32 s66, s53, 1
  s_add_u32 s66, s66, s64
  s_add_u32 m0, s37, 44928
s_nop 0
  buffer_load_dwordx4 v24, s[8:11], s79 offen offset:128 lds
  v_lshl_add_u32 v57, v87, 1, s66
  v_add_u32 v59, 3, v54
  s_mov_b64 exec, s[86:87]
  ds_write_b16 v57, v59 offset:0
  ds_write_b16_d16_hi v57, v81 offset:3648
  s_mov_b64 exec, -1
  s_lshl_b32 s65, s65, 6
  s_add_u32 s65, s65, s45
  s_lshl_b32 s66, s54, 1
  s_add_u32 s66, s66, s65
  v_lshl_add_u32 v55, v88, 1, s66
  v_add_u32 v56, 200, v54
  s_mov_b64 exec, s[88:89]
  ds_write_b16 v55, v56 offset:0
  ds_write_b16 v55, v82 offset:3648
  s_mov_b64 exec, -1
  s_lshl_b32 s66, s55, 1
  s_add_u32 s66, s66, s65
  s_add_u32 s79, s3, 49152
  s_add_u32 m0, s37, 49152
s_nop 0
  buffer_load_dwordx4 v24, s[8:11], s79 offen lds
  v_lshl_add_u32 v57, v89, 1, s66
  v_add_u32 v59, 201, v54
  s_mov_b64 exec, s[90:91]
  ds_write_b16 v57, v59 offset:0
  ds_write_b16_d16_hi v57, v82 offset:3648
  s_mov_b64 exec, -1
  s_lshl_b32 s66, s56, 1
  s_add_u32 s66, s66, s65
  v_lshl_add_u32 v55, v90, 1, s66
  v_add_u32 v56, 202, v54
  s_mov_b64 exec, s[92:93]
  ds_write_b16 v55, v56 offset:0
  ds_write_b16 v55, v83 offset:3648
  s_mov_b64 exec, -1
  s_lshl_b32 s66, s57, 1
  s_add_u32 s66, s66, s65
  v_lshl_add_u32 v57, v91, 1, s66
  s_add_u32 m0, s37, 53120
s_nop 0
  buffer_load_dwordx4 v24, s[8:11], s79 offen offset:128 lds
  v_add_u32 v59, 203, v54
  s_mov_b64 exec, s[94:95]
  ds_write_b16 v57, v59 offset:0
  ds_write_b16_d16_hi v57, v83 offset:3648
  s_mov_b64 exec, -1
  s_mov_b32 s39, s78
  s_mov_b64 s[40:41], 0
  s_mov_b64 s[42:43], 0
  s_add_u32 s68, s71, 1
  s_lshl_b64 s[66:67], 1, s68
  s_or_b64 s[42:43], s[42:43], s[66:67]
  s_lshl_b64 s[66:67], 1, s71
  s_or_b64 s[40:41], s[40:41], s[66:67]
  s_add_u32 s68, s72, 1
  s_lshl_b64 s[66:67], 1, s68
  s_or_b64 s[42:43], s[42:43], s[66:67]
  s_lshl_b64 s[66:67], 1, s72
  s_or_b64 s[40:41], s[40:41], s[66:67]
  s_add_u32 s79, s3, 57344
  s_add_u32 m0, s37, 57344
s_nop 0
  buffer_load_dwordx4 v24, s[8:11], s79 offen lds
  s_add_u32 s68, s73, 1
  s_lshl_b64 s[66:67], 1, s68
  s_or_b64 s[42:43], s[42:43], s[66:67]
  s_lshl_b64 s[66:67], 1, s73
  s_or_b64 s[40:41], s[40:41], s[66:67]
  s_add_u32 s68, s74, 1
  s_lshl_b64 s[66:67], 1, s68
  s_or_b64 s[42:43], s[42:43], s[66:67]
  s_lshl_b64 s[66:67], 1, s74
  s_or_b64 s[40:41], s[40:41], s[66:67]
  s_add_u32 s68, s75, 1
  s_lshl_b64 s[66:67], 1, s68
  s_or_b64 s[42:43], s[42:43], s[66:67]
  s_lshl_b64 s[66:67], 1, s75
  s_or_b64 s[40:41], s[40:41], s[66:67]
  s_add_u32 s68, s76, 1
  s_lshl_b64 s[66:67], 1, s68
  s_add_u32 m0, s37, 61312
s_nop 0
  buffer_load_dwordx4 v24, s[8:11], s79 offen offset:128 lds
  s_or_b64 s[42:43], s[42:43], s[66:67]
  s_lshl_b64 s[66:67], 1, s76
  s_or_b64 s[40:41], s[40:41], s[66:67]
  s_add_u32 s68, s77, 1
  s_lshl_b64 s[66:67], 1, s68
  s_or_b64 s[42:43], s[42:43], s[66:67]
  s_lshl_b64 s[66:67], 1, s77
  s_or_b64 s[40:41], s[40:41], s[66:67]
  s_add_u32 s68, s78, 1
  s_lshl_b64 s[66:67], 1, s68
  s_or_b64 s[42:43], s[42:43], s[66:67]
  s_sub_u32 s68, s39, 1
  s_lshl_b64 s[34:35], 1, s68
  s_waitcnt vmcnt(8) lgkmcnt(0)
  s_barrier
  ds_read_b128 v[64:67], v136
  ds_read_b128 v[68:71], v137
  ds_read_b128 v[72:75], v138
  ds_read_b128 v[76:79], v139
  ds_read_b128 v[80:83], v140
  ds_read_b128 v[84:87], v141
  ds_read_b128 v[88:91], v142
  ds_read_b128 v[92:95], v143
  ds_read_b64_tr_b16 v[96:97], v188 offset:0
  ds_read_b64_tr_b16 v[98:99], v189 offset:0
  ds_read_b64_tr_b16 v[100:101], v190 offset:0
  ds_read_b64_tr_b16 v[102:103], v191 offset:0
  ds_read_b64_tr_b16 v[224:225], v28 offset:0
  ds_read_b64_tr_b16 v[226:227], v29 offset:0
  ds_read_b64_tr_b16 v[228:229], v30 offset:0
  ds_read_b64_tr_b16 v[230:231], v31 offset:0
  ds_read_u16_d16_hi v168, v128 offset:0
  ds_read_u16_d16_hi v169, v129 offset:256
  ds_read_u16_d16_hi v170, v130 offset:512
  ds_read_u16_d16_hi v171, v131 offset:768
  ds_read_u16_d16_hi v172, v132 offset:1024
  ds_read_u16_d16_hi v173, v133 offset:1280
  ds_read_u16_d16_hi v174, v134 offset:1536
  ds_read_u16_d16_hi v175, v135 offset:1792
  ds_read_b64_tr_b16 v[104:105], v188 offset:8192
  ds_read_b64_tr_b16 v[106:107], v189 offset:8192
  ds_read_b64_tr_b16 v[108:109], v190 offset:8192
  ds_read_b64_tr_b16 v[110:111], v191 offset:8192
  ds_read_b64_tr_b16 v[232:233], v28 offset:8192
  ds_read_b64_tr_b16 v[234:235], v29 offset:8192
  ds_read_b64_tr_b16 v[236:237], v30 offset:8192
  ds_read_b64_tr_b16 v[238:239], v31 offset:8192
  s_waitcnt lgkmcnt(15)
  v_mfma_f32_32x32x16_bf16 v[48:63], v[96:99], v[64:67], 0
  ds_read_b64_tr_b16 v[112:113], v188 offset:16384
  ds_read_b64_tr_b16 v[114:115], v189 offset:16384
  ds_read_b64_tr_b16 v[116:117], v190 offset:16384
  v_mfma_f32_32x32x16_bf16 v[48:63], v[100:103], v[68:71], v[48:63]
  ds_read_b64_tr_b16 v[118:119], v191 offset:16384
  ds_read_b64_tr_b16 v[240:241], v28 offset:16384
  ds_read_b64_tr_b16 v[242:243], v29 offset:16384
  v_mfma_f32_32x32x16_bf16 v[128:143], v[32:35], v[224:227], 0
  ds_read_b64_tr_b16 v[244:245], v30 offset:16384
  ds_read_b64_tr_b16 v[246:247], v31 offset:16384
  ds_read_u16 v176, v8 offset:0
  ds_read_u16 v22, v8 offset:64
  v_mfma_f32_32x32x16_bf16 v[128:143], v[36:39], v[228:231], v[128:143]
  ds_read_u16 v23, v8 offset:128
  ds_read_u16 v12, v8 offset:192
  ds_read_u16 v13, v8 offset:256
  v_mfma_f32_32x32x16_bf16 v[128:143], v[32:35], v[96:99], v[128:143]
  ds_read_u16 v9, v8 offset:320
  v_mul_f32 v168, s48, v168
  s_waitcnt lgkmcnt(15)
  v_mul_f32 v169, s48, v169
  v_mfma_f32_32x32x16_bf16 v[128:143], v[36:39], v[100:103], v[128:143]
  v_mul_f32 v170, s48, v170
  v_mul_f32 v171, s48, v171
  v_mul_f32 v172, s48, v172
  v_mul_f32 v173, s48, v173
  v_mfma_f32_32x32x16_bf16 v[48:63], v[104:107], v[72:75], v[48:63]
  ds_read_b64_tr_b16 v[120:121], v188 offset:24576
  ds_read_b64_tr_b16 v[122:123], v189 offset:24576
  ds_read_b64_tr_b16 v[124:125], v190 offset:24576
  ds_read_b64_tr_b16 v[126:127], v191 offset:24576
  v_mfma_f32_32x32x16_bf16 v[48:63], v[108:111], v[76:79], v[48:63]
  ds_read_b64_tr_b16 v[248:249], v28 offset:24576
  ds_read_b64_tr_b16 v[250:251], v29 offset:24576
  ds_read_b64_tr_b16 v[252:253], v30 offset:24576
  ds_read_b64_tr_b16 v[254:255], v31 offset:24576
  ds_read_b64 v[160:161], v180 offset:0
  v_mfma_f32_32x32x16_bf16 v[144:159], v[32:35], v[232:235], 0
  ds_read_b64 v[162:163], v180 offset:16
  ds_read_b64 v[164:165], v180 offset:32
  ds_read_b64 v[166:167], v180 offset:48
  ds_read_b64 v[40:41], v181 offset:0
  ds_read_b64 v[42:43], v181 offset:16
  s_waitcnt lgkmcnt(15)
  v_mfma_f32_32x32x16_bf16 v[144:159], v[36:39], v[236:239], v[144:159]
  ds_read_b64 v[44:45], v181 offset:32
  ds_read_b64 v[46:47], v181 offset:48
  v_mul_f32 v174, s48, v174
  v_mul_f32 v175, s48, v175
  v_mfma_f32_32x32x16_bf16 v[144:159], v[32:35], v[104:107], v[144:159]
  v_cvt_pk_bf16_f32 v24, v168, v169
  v_cvt_pk_bf16_f32 v25, v170, v171
  v_cvt_pk_bf16_f32 v26, v172, v173
  v_cvt_pk_bf16_f32 v27, v174, v175
  ds_write_b16 v18, v24
  v_mfma_f32_32x32x16_bf16 v[144:159], v[36:39], v[108:111], v[144:159]
  v_alignbit_b32 v24, v25, v24, 16
  v_alignbit_b32 v25, v26, v25, 16
  v_alignbit_b32 v26, v27, v26, 16
  v_lshrrev_b32 v27, 16, v27
  v_add_u32 v18, 2112, v18
  v_lshl_add_u32 v176, v176, 8, v10
  v_lshl_add_u32 v22, v22, 8, v10
  v_lshl_add_u32 v23, v23, 8, v10
  v_lshl_add_u32 v12, v12, 8, v10
  v_lshl_add_u32 v13, v13, 8, v10
  s_waitcnt vmcnt(0) lgkmcnt(0)
  s_barrier
  v_mfma_f32_32x32x16_bf16 v[48:63], v[112:115], v[80:83], v[48:63]
  s_add_u32 m0, s37, 0
s_nop 0
  buffer_load_dwordx4 v176, s[4:7], 0 offen nt lds
  ds_read_b64_tr_b16 v[96:97], v28 offset:32768
  ds_read_b64_tr_b16 v[98:99], v29 offset:32768
  ds_read_b64_tr_b16 v[100:101], v30 offset:32768
  ds_read_b64_tr_b16 v[102:103], v31 offset:32768
  v_mfma_f32_32x32x16_bf16 v[48:63], v[116:119], v[84:87], v[48:63]
  s_add_u32 m0, s37, 3968
s_nop 0
  buffer_load_dwordx4 v176, s[4:7], 0 offen offset:128 nt lds
  ds_read_b64_tr_b16 v[104:105], v28 offset:40960
  ds_read_b64_tr_b16 v[106:107], v29 offset:40960
  ds_read_b64_tr_b16 v[108:109], v30 offset:40960
  ds_read_b64_tr_b16 v[110:111], v31 offset:40960
  v_add_u32 v28, 0x10000, v28
  v_add_u32 v29, 0x10000, v29
  v_add_u32 v30, 0x10000, v30
  v_add_u32 v31, 0x10000, v31
  v_mfma_f32_32x32x16_bf16 v[48:63], v[120:123], v[88:91], v[48:63]
  ds_read_b64_tr_b16 v[192:193], v28 offset:32768
  ds_read_b64_tr_b16 v[194:195], v29 offset:32768
  ds_read_b64_tr_b16 v[196:197], v30 offset:32768
  ds_read_b64_tr_b16 v[198:199], v31 offset:32768
  v_lshlrev_b32 v176, 16, v160
  v_and_b32 v177, 0xffff0000, v160
  v_lshlrev_b32 v178, 16, v161
  v_and_b32 v179, 0xffff0000, v161
  v_lshlrev_b32 v180, 16, v162
  v_and_b32 v181, 0xffff0000, v162
  v_lshlrev_b32 v182, 16, v163
  v_and_b32 v183, 0xffff0000, v163
  v_mfma_f32_32x32x16_bf16 v[48:63], v[124:127], v[92:95], v[48:63]
  ds_read_b64_tr_b16 v[200:201], v28 offset:40960
  ds_read_b64_tr_b16 v[202:203], v29 offset:40960
  ds_read_b64_tr_b16 v[204:205], v30 offset:40960
  ds_read_b64_tr_b16 v[206:207], v31 offset:40960
  v_lshlrev_b32 v184, 16, v164
  v_and_b32 v185, 0xffff0000, v164
  v_lshlrev_b32 v186, 16, v165
  v_and_b32 v187, 0xffff0000, v165
  v_lshlrev_b32 v188, 16, v166
  v_and_b32 v189, 0xffff0000, v166
  v_lshlrev_b32 v190, 16, v167
  v_and_b32 v191, 0xffff0000, v167
  v_mfma_f32_32x32x16_bf16 v[160:175], v[32:35], v[240:243], 0
  ds_read_b64_tr_b16 v[208:209], v28 offset:49152
  ds_read_b64_tr_b16 v[210:211], v29 offset:49152
  ds_read_b64_tr_b16 v[212:213], v30 offset:49152
  ds_read_b64_tr_b16 v[214:215], v31 offset:49152
  ds_read_b64_tr_b16 v[216:217], v28 offset:57344
  ds_read_b64_tr_b16 v[218:219], v29 offset:57344
  ds_read_b64_tr_b16 v[220:221], v30 offset:57344
  v_mfma_f32_32x32x16_bf16 v[160:175], v[36:39], v[244:247], v[160:175]
  ds_read_b64_tr_b16 v[222:223], v31 offset:57344
  v_subrev_u32 v28, 0x10000, v28
  v_subrev_u32 v29, 0x10000, v29
  v_subrev_u32 v30, 0x10000, v30
  v_subrev_u32 v31, 0x10000, v31
  v_sub_f32 v48, v176, v48
  v_sub_f32 v49, v177, v49
  v_mfma_f32_32x32x16_bf16 v[160:175], v[32:35], v[112:115], v[160:175]
  s_add_u32 m0, s37, 8192
s_nop 0
  buffer_load_dwordx4 v22, s[4:7], 0 offen nt lds
  v_sub_f32 v50, v178, v50
  v_sub_f32 v51, v179, v51
  v_sub_f32 v52, v180, v52
  v_sub_f32 v53, v181, v53
  v_sub_f32 v54, v182, v54
  v_sub_f32 v55, v183, v55
  v_sub_f32 v56, v184, v56
  v_mfma_f32_32x32x16_bf16 v[160:175], v[36:39], v[116:119], v[160:175]
  v_sub_f32 v57, v185, v57
  v_sub_f32 v58, v186, v58
  v_sub_f32 v59, v187, v59
  v_sub_f32 v60, v188, v60
  v_sub_f32 v61, v189, v61
  v_sub_f32 v62, v190, v62
  v_sub_f32 v63, v191, v63
  v_mfma_f32_32x32x16_bf16 v[176:191], v[32:35], v[248:251], 0
  ds_read_b64_tr_b16 v[112:113], v28 offset:49152
  ds_read_b64_tr_b16 v[114:115], v29 offset:49152
  ds_read_b64_tr_b16 v[116:117], v30 offset:49152
  ds_read_b64_tr_b16 v[118:119], v31 offset:49152
  v_mul_f32 v128, s48, v128
  v_mul_f32 v129, s48, v129
  v_mul_f32 v130, s48, v130
  v_mul_f32 v131, s48, v131
  v_mul_f32 v132, s48, v132
  v_mul_f32 v133, s48, v133
  v_mfma_f32_32x32x16_bf16 v[176:191], v[36:39], v[252:255], v[176:191]
  s_add_u32 m0, s37, 12160
s_nop 0
  buffer_load_dwordx4 v22, s[4:7], 0 offen offset:128 nt lds
  v_mul_f32 v134, s48, v134
  v_mul_f32 v135, s48, v135
  v_mul_f32 v136, s48, v136
  v_mul_f32 v137, s48, v137
  v_mul_f32 v138, s48, v138
  v_mul_f32 v139, s48, v139
  v_mfma_f32_32x32x16_bf16 v[176:191], v[32:35], v[120:123], v[176:191]
  v_mul_f32 v140, s48, v140
  v_mul_f32 v141, s48, v141
  v_mul_f32 v142, s48, v142
  v_mul_f32 v143, s48, v143
  v_mul_f32 v144, s48, v144
  v_mul_f32 v145, s48, v145
  v_mul_f32 v146, s48, v146
  v_mul_f32 v147, s48, v147
  v_mfma_f32_32x32x16_bf16 v[176:191], v[36:39], v[124:127], v[176:191]
  ds_read_b64_tr_b16 v[120:121], v28 offset:57344
  ds_read_b64_tr_b16 v[122:123], v29 offset:57344
  ds_read_b64_tr_b16 v[124:125], v30 offset:57344
  ds_read_b64_tr_b16 v[126:127], v31 offset:57344
  v_mul_f32 v148, s48, v148
  v_mul_f32 v149, s48, v149
  v_mul_f32 v150, s48, v150
  v_mul_f32 v151, s48, v151
  ds_read_b128 v[224:227], v16 offset:0
  ds_read_b128 v[228:231], v17 offset:0
  ds_read_b128 v[232:235], v16 offset:528
  ds_read_b128 v[236:239], v17 offset:528
  ds_read_b128 v[240:243], v16 offset:1056
  ds_read_b128 v[244:247], v17 offset:1056
  ds_read_b128 v[248:251], v16 offset:1584
  ds_read_b128 v[252:255], v17 offset:1584
  s_waitcnt lgkmcnt(15)
  v_mfma_f32_32x32x16_bf16 v[48:63], v[96:99], v[64:67], v[48:63]
  s_add_u32 m0, s37, 16384
s_nop 0
  buffer_load_dwordx4 v23, s[4:7], 0 offen nt lds
  v_mul_f32 v152, s48, v152
  v_mul_f32 v153, s48, v153
  v_mul_f32 v154, s48, v154
  v_mul_f32 v155, s48, v155
  v_mfma_f32_32x32x16_bf16 v[48:63], v[100:103], v[68:71], v[48:63]
  v_mul_f32 v156, s48, v156
  v_mul_f32 v157, s48, v157
  v_mul_f32 v158, s48, v158
  v_mul_f32 v159, s48, v159
  v_mul_f32 v160, s48, v160
  v_mul_f32 v161, s48, v161
  v_mfma_f32_32x32x16_bf16 v[48:63], v[104:107], v[72:75], v[48:63]
  v_mul_f32 v162, s48, v162
  v_mul_f32 v163, s48, v163
  v_mul_f32 v164, s48, v164
  v_mul_f32 v165, s48, v165
  v_mfma_f32_32x32x16_bf16 v[48:63], v[108:111], v[76:79], v[48:63]
  s_add_u32 m0, s37, 20352
s_nop 0
  buffer_load_dwordx4 v23, s[4:7], 0 offen offset:128 nt lds
  v_mul_f32 v166, s48, v166
  v_mul_f32 v167, s48, v167
  v_mul_f32 v168, s48, v168
  v_mul_f32 v169, s48, v169
  v_mul_f32 v170, s48, v170
  v_mul_f32 v171, s48, v171
  s_waitcnt lgkmcnt(14)
  v_mfma_f32_32x32x16_bf16 v[48:63], v[112:115], v[80:83], v[48:63]
  v_mul_f32 v172, s48, v172
  v_mul_f32 v173, s48, v173
  v_mul_f32 v174, s48, v174
  v_mul_f32 v175, s48, v175
  s_waitcnt lgkmcnt(12)
  v_mfma_f32_32x32x16_bf16 v[48:63], v[116:119], v[84:87], v[48:63]
  v_mul_f32 v176, s48, v176
  v_mul_f32 v177, s48, v177
  v_mul_f32 v178, s48, v178
  v_mul_f32 v179, s48, v179
  v_mul_f32 v180, s48, v180
  v_mul_f32 v181, s48, v181
  s_waitcnt lgkmcnt(10)
  v_mfma_f32_32x32x16_bf16 v[48:63], v[120:123], v[88:91], v[48:63]
  s_add_u32 m0, s37, 24576
s_nop 0
  buffer_load_dwordx4 v12, s[4:7], 0 offen nt lds
  v_mul_f32 v182, s48, v182
  v_mul_f32 v183, s48, v183
  v_mul_f32 v184, s48, v184
  v_mul_f32 v185, s48, v185
  s_waitcnt lgkmcnt(8)
  v_mfma_f32_32x32x16_bf16 v[48:63], v[124:127], v[92:95], v[48:63]
  v_mul_f32 v186, s48, v186
  v_mul_f32 v187, s48, v187
  v_mul_f32 v188, s48, v188
  v_mul_f32 v189, s48, v189
  v_mul_f32 v190, s48, v190
  v_mul_f32 v191, s48, v191
  v_mov_b32 v28, 138824
  s_mov_b64 exec, 1
  ds_inc_u32 v28, v28
  s_mov_b64 exec, -1
  s_lshl_b32 s49, s49, 16
  s_cmp_eq_u32 s36, 0
  s_cselect_b32 s49, s49, 0
  s_waitcnt lgkmcnt(8)
  v_mfma_f32_32x32x16_bf16 v[64:79], v[224:227], v[192:195], v[128:143]
  ds_write_b16 v18, v24
  v_alignbit_b32 v24, v25, v24, 16
  v_alignbit_b32 v25, v26, v25, 16
  v_alignbit_b32 v26, v27, v26, 16
  v_lshrrev_b32 v27, 16, v27
  s_waitcnt lgkmcnt(8)
  v_mfma_f32_32x32x16_bf16 v[64:79], v[228:231], v[196:199], v[64:79]
  s_add_u32 m0, s37, 28544
s_nop 0
  buffer_load_dwordx4 v12, s[4:7], 0 offen offset:128 nt lds
  v_add_u32 v16, s44, v16
  v_add_u32 v17, s44, v17
  s_sub_u32 s44, 0, s44
  v_add_u32 v18, s44, v18
  v_mov_b32 v32, 0
  v_mov_b32 v33, 0
  v_mov_b32 v34, 0
  v_mov_b32 v35, 0
  s_waitcnt lgkmcnt(7)
  v_mfma_f32_32x32x16_bf16 v[80:95], v[232:235], v[200:203], v[144:159]
  v_mov_b32 v36, 0
  v_mov_b32 v37, 0
  v_mov_b32 v38, 0
  v_mov_b32 v39, 0
  v_mov_b32 v28, 0
  v_mov_b32 v29, 0
  v_mov_b32 v30, 0
  v_mov_b32 v31, 0
  s_waitcnt lgkmcnt(6)
  v_mfma_f32_32x32x16_bf16 v[80:95], v[236:239], v[204:207], v[80:95]
  v_mul_f32 v48, s48, v48
  v_mul_f32 v49, s48, v49
  v_mul_f32 v50, s48, v50
  v_mul_f32 v51, s48, v51
  ds_write_b128 v21, v[48:51] offset:0
  s_waitcnt lgkmcnt(6)
  v_mfma_f32_32x32x16_bf16 v[96:111], v[240:243], v[208:211], v[160:175]
  v_mul_f32 v52, s48, v52
  v_mul_f32 v53, s48, v53
  v_mul_f32 v54, s48, v54
  v_mul_f32 v55, s48, v55
  ds_write_b128 v21, v[52:55] offset:32
  s_waitcnt lgkmcnt(6)
  v_mfma_f32_32x32x16_bf16 v[96:111], v[244:247], v[212:215], v[96:111]
  v_mul_f32 v56, s48, v56
  v_mul_f32 v57, s48, v57
  v_mul_f32 v58, s48, v58
  v_mul_f32 v59, s48, v59
  ds_write_b128 v21, v[56:59] offset:64
  s_waitcnt lgkmcnt(6)
  v_mfma_f32_32x32x16_bf16 v[112:127], v[248:251], v[216:219], v[176:191]
  v_mul_f32 v60, s48, v60
  v_mul_f32 v61, s48, v61
  v_mul_f32 v62, s48, v62
  v_mul_f32 v63, s48, v63
  ds_write_b128 v21, v[60:63] offset:96
  s_waitcnt lgkmcnt(6)
  v_mfma_f32_32x32x16_bf16 v[112:127], v[252:255], v[220:223], v[112:127]
  v_cvt_pk_bf16_f32 v224, v64, v65
  v_cvt_pk_bf16_f32 v225, v66, v67
  v_cvt_pk_bf16_f32 v226, v68, v69
  v_cvt_pk_bf16_f32 v227, v70, v71
  v_cvt_pk_bf16_f32 v228, v72, v73
  v_cvt_pk_bf16_f32 v229, v74, v75
  v_cvt_pk_bf16_f32 v230, v76, v77
  v_cvt_pk_bf16_f32 v231, v78, v79
  s_waitcnt lgkmcnt(0)
  ds_read_b128 v[48:51], v19 offset:0
  ds_read_b128 v[52:55], v19 offset:32
  ds_read_b128 v[56:59], v19 offset:64
  ds_read_b128 v[60:63], v19 offset:96
  v_add_u32 v19, 0x200, v19
  v_cvt_pk_bf16_f32 v232, v80, v81
  v_cvt_pk_bf16_f32 v233, v82, v83
  v_cvt_pk_bf16_f32 v234, v84, v85
  v_cvt_pk_bf16_f32 v235, v86, v87
  v_cvt_pk_bf16_f32 v236, v88, v89
  v_cvt_pk_bf16_f32 v237, v90, v91
  v_cvt_pk_bf16_f32 v238, v92, v93
  v_cvt_pk_bf16_f32 v239, v94, v95
  v_mov_b32 v22, s49
  v_mov_b32 v23, s49
  v_mov_b32 v64, 0
  v_mov_b32 v65, 0
  v_mov_b32 v66, 0
  v_mov_b32 v67, 0
  v_mov_b32 v68, 0
  v_mov_b32 v69, 0
  v_mov_b32 v70, 0
  v_mov_b32 v71, 0
  v_cvt_pk_bf16_f32 v240, v96, v97
  v_cvt_pk_bf16_f32 v241, v98, v99
  v_cvt_pk_bf16_f32 v242, v100, v101
  v_cvt_pk_bf16_f32 v243, v102, v103
  v_cvt_pk_bf16_f32 v244, v104, v105
  v_cvt_pk_bf16_f32 v245, v106, v107
  v_cvt_pk_bf16_f32 v246, v108, v109
  v_cvt_pk_bf16_f32 v247, v110, v111
  v_cvt_pk_bf16_f32 v248, v112, v113
  v_cvt_pk_bf16_f32 v249, v114, v115
  v_cvt_pk_bf16_f32 v250, v116, v117
  v_cvt_pk_bf16_f32 v251, v118, v119
  v_cvt_pk_bf16_f32 v252, v120, v121
  v_cvt_pk_bf16_f32 v253, v122, v123
  v_cvt_pk_bf16_f32 v254, v124, v125
  v_cvt_pk_bf16_f32 v255, v126, v127
  v_mov_b32 v12, 0
  s_waitcnt vmcnt(6) lgkmcnt(0)
  s_mov_b64 exec, 1
  ds_inc_u32 v15, v15 offset:512
  s_mov_b64 exec, -1
  v_mov_b32 v21, 138824
LS_b4:
  ds_read_b32 v28, v15 offset:512
  ds_read_b32 v29, v21
  s_waitcnt lgkmcnt(0)
  v_readfirstlane_b32 s50, v28
  v_readfirstlane_b32 s51, v29
s_nop 0
  s_lshr_b32 s51, s51, 1
  s_min_u32 s50, s50, s51
  s_cmp_ge_u32 s50, 4
  s_cbranch_scc0 LS_b4
  v_mov_b32 v28, 0
  v_mov_b32 v29, 0
  s_add_u32 m0, s37, 32768
s_nop 0
  buffer_load_dwordx4 v13, s[4:7], 0 offen nt lds
  s_add_u32 m0, s37, 36736
s_nop 0
  buffer_load_dwordx4 v13, s[4:7], 0 offen offset:128 nt lds
  v_mov_b32 v13, 0
  s_mov_b32 s92, 4
  s_mov_b32 s68, 1.0
  s_mov_b32 s69, 1.0
  s_cmp_eq_u32 s38, 1
  s_cbranch_scc1 LA_entry
  s_setprio 3
LB_b0:
  ds_read_b128 v[96:99], v0 offset:0
  ds_read_b128 v[100:103], v1 offset:0
  ds_read_b128 v[104:107], v2 offset:0
  ds_read_b128 v[108:111], v3 offset:0
  v_mfma_f32_16x16x32_bf16 v[28:31], v[40:43], v[64:67], v[22:25]
  ds_read_b128 v[112:115], v0 offset:4096
  ds_read_b128 v[116:119], v1 offset:4096
  v_mfma_f32_16x16x32_bf16 v[28:31], v[44:47], v[68:71], v[28:31]
  ds_read_b128 v[120:123], v2 offset:4096
  ds_read_b128 v[124:127], v3 offset:4096
  v_lshl_add_u32 v21, v9, 8, v10
  s_add_u32 m0, s37, 40960
  ds_read_b128 v[88:91], v15 offset:0
  buffer_load_dwordx4 v21, s[4:7], 0 offen nt lds
  s_waitcnt lgkmcnt(8)
  v_mfma_f32_32x32x16_bf16 v[64:79], v[224:227], v[96:99], v[48:63]
  v_mul_f32 v28, v28, v12
  v_mul_f32 v29, v29, v13
  v_cvt_pk_bf16_f32 v28, v28, v29
  ds_write_b32 v14, v28 offset:256
  s_waitcnt lgkmcnt(8)
  v_mfma_f32_32x32x16_bf16 v[64:79], v[228:231], v[100:103], v[64:79]
  s_add_u32 m0, s37, 44928
  ds_read_b64_tr_b16 v[80:81], v4 offset:49152
  buffer_load_dwordx4 v21, s[4:7], 0 offen offset:128 nt lds
  ds_read_b64_tr_b16 v[82:83], v6 offset:49152
  s_waitcnt lgkmcnt(9)
  v_mfma_f32_32x32x16_bf16 v[64:79], v[232:235], v[104:107], v[64:79]
  ds_read_b64_tr_b16 v[84:85], v5 offset:49152
  ds_read_b64_tr_b16 v[86:87], v7 offset:49152
  ds_read_u16 v9, v8 offset:384
  s_waitcnt lgkmcnt(11)
  v_mfma_f32_32x32x16_bf16 v[64:79], v[236:239], v[108:111], v[64:79]
  ds_read_u16_d16_hi v12, v11 offset:64
  ds_read_u16_d16_hi v13, v11 offset:96
  s_add_u32 s92, s92, 4
  s_bitcmp1_b32 s34, 0
  s_cselect_b32 s93, -1, s92
  s_waitcnt lgkmcnt(12)
  v_mfma_f32_32x32x16_bf16 v[64:79], v[240:243], v[112:115], v[64:79]
  s_waitcnt lgkmcnt(11)
  v_mfma_f32_32x32x16_bf16 v[64:79], v[244:247], v[116:119], v[64:79]
  s_waitcnt lgkmcnt(10)
  v_mfma_f32_32x32x16_bf16 v[64:79], v[248:251], v[120:123], v[64:79]
  s_waitcnt lgkmcnt(9)
  v_mfma_f32_32x32x16_bf16 v[64:79], v[252:255], v[124:127], v[64:79]
  s_waitcnt lgkmcnt(5)
  v_mfma_f32_16x16x32_bf16 v[32:35], v[88:91], v[80:83], v[32:35]
  s_waitcnt lgkmcnt(3)
  v_mfma_f32_16x16x32_bf16 v[36:39], v[88:91], v[84:87], v[36:39]
  s_bitcmp1_b32 s40, 1
  s_cbranch_scc1 LB_first0
  s_bitcmp1_b32 s42, 0
  s_waitcnt vmcnt(8)
  s_mov_b64 exec, 1
  ds_inc_u32 v15, v15 offset:512
  s_mov_b64 exec, -1
  s_cbranch_scc1 LB_epi0
LB_done0:
  s_setprio 0
  v_exp_f32 v64, v64
  v_exp_f32 v65, v65
  v_exp_f32 v66, v66
  v_exp_f32 v67, v67
  v_exp_f32 v68, v68
  v_exp_f32 v69, v69
  v_exp_f32 v70, v70
  v_exp_f32 v71, v71
  v_exp_f32 v72, v72
  v_exp_f32 v73, v73
  v_exp_f32 v74, v74
  v_exp_f32 v75, v75
  v_exp_f32 v76, v76
  v_exp_f32 v77, v77
  v_exp_f32 v78, v78
  v_exp_f32 v79, v79
  v_add_f32 v64, 1.0, v64
  v_add_f32 v65, 1.0, v65
  v_add_f32 v66, 1.0, v66
  v_add_f32 v67, 1.0, v67
  v_add_f32 v68, 1.0, v68
  v_add_f32 v69, 1.0, v69
  v_add_f32 v70, 1.0, v70
  v_add_f32 v71, 1.0, v71
  s_setprio 2
  v_add_f32 v72, 1.0, v72
  v_add_f32 v73, 1.0, v73
  v_add_f32 v74, 1.0, v74
  v_add_f32 v75, 1.0, v75
  v_add_f32 v76, 1.0, v76
  v_add_f32 v77, 1.0, v77
  v_add_f32 v78, 1.0, v78
  v_add_f32 v79, 1.0, v79
  v_rcp_f32 v64, v64
  v_rcp_f32 v65, v65
  v_rcp_f32 v66, v66
  v_rcp_f32 v67, v67
  v_rcp_f32 v68, v68
  v_rcp_f32 v69, v69
  v_rcp_f32 v70, v70
  v_rcp_f32 v71, v71
  v_cvt_pk_bf16_f32 v64, v64, v65
  v_cvt_pk_bf16_f32 v65, v66, v67
  v_cvt_pk_bf16_f32 v66, v68, v69
  v_cvt_pk_bf16_f32 v67, v70, v71
  v_rcp_f32 v72, v72
  v_rcp_f32 v73, v73
  ds_read_b32 v21, v15 offset:512
  v_rcp_f32 v74, v74
  v_rcp_f32 v75, v75
  v_rcp_f32 v76, v76
  v_rcp_f32 v77, v77
  v_rcp_f32 v78, v78
  v_rcp_f32 v79, v79
  v_cvt_pk_bf16_f32 v68, v72, v73
  v_cvt_pk_bf16_f32 v69, v74, v75
  v_cvt_pk_bf16_f32 v70, v76, v77
  v_cvt_pk_bf16_f32 v71, v78, v79
LB_vj0:
  s_waitcnt lgkmcnt(0)
  v_readfirstlane_b32 s55, v21
  s_setprio 3
  s_cmp_ge_u32 s55, s93
  s_cbranch_scc0 LB_slow0
LB_b1:
  ds_read_b128 v[96:99], v0 offset:8192
  ds_read_b128 v[100:103], v1 offset:8192
  ds_read_b128 v[104:107], v2 offset:8192
  ds_read_b128 v[108:111], v3 offset:8192
  v_mfma_f32_16x16x32_bf16 v[28:31], v[40:43], v[64:67], v[22:25]
  ds_read_b128 v[112:115], v0 offset:12288
  ds_read_b128 v[116:119], v1 offset:12288
  v_mfma_f32_16x16x32_bf16 v[28:31], v[44:47], v[68:71], v[28:31]
  ds_read_b128 v[120:123], v2 offset:12288
  ds_read_b128 v[124:127], v3 offset:12288
  v_lshl_add_u32 v21, v9, 8, v10
  s_add_u32 m0, s37, 49152
  ds_read_b128 v[88:91], v15 offset:256
  buffer_load_dwordx4 v21, s[4:7], 0 offen nt lds
  s_waitcnt lgkmcnt(8)
  v_mfma_f32_32x32x16_bf16 v[64:79], v[224:227], v[96:99], v[48:63]
  v_mul_f32 v28, v28, v12
  v_mul_f32 v29, v29, v13
  v_cvt_pk_bf16_f32 v28, v28, v29
  ds_write_b32 v14, v28 offset:0
  s_waitcnt lgkmcnt(8)
  v_mfma_f32_32x32x16_bf16 v[64:79], v[228:231], v[100:103], v[64:79]
  s_add_u32 m0, s37, 53120
  ds_read_b64_tr_b16 v[80:81], v4 offset:57344
  buffer_load_dwordx4 v21, s[4:7], 0 offen offset:128 nt lds
  ds_read_b64_tr_b16 v[82:83], v6 offset:57344
  s_waitcnt lgkmcnt(9)
  v_mfma_f32_32x32x16_bf16 v[64:79], v[232:235], v[104:107], v[64:79]
  ds_read_b64_tr_b16 v[84:85], v5 offset:57344
  ds_read_b64_tr_b16 v[86:87], v7 offset:57344
  ds_read_u16 v9, v8 offset:448
  s_waitcnt lgkmcnt(11)
  v_mfma_f32_32x32x16_bf16 v[64:79], v[236:239], v[108:111], v[64:79]
  ds_read_u16_d16_hi v12, v11 offset:128
  ds_read_u16_d16_hi v13, v11 offset:160
  s_add_u32 s92, s92, 4
  s_bitcmp1_b32 s34, 1
  s_cselect_b32 s93, -1, s92
  s_waitcnt lgkmcnt(12)
  v_mfma_f32_32x32x16_bf16 v[64:79], v[240:243], v[112:115], v[64:79]
  s_waitcnt lgkmcnt(11)
  v_mfma_f32_32x32x16_bf16 v[64:79], v[244:247], v[116:119], v[64:79]
  s_waitcnt lgkmcnt(10)
  v_mfma_f32_32x32x16_bf16 v[64:79], v[248:251], v[120:123], v[64:79]
  s_waitcnt lgkmcnt(9)
  v_mfma_f32_32x32x16_bf16 v[64:79], v[252:255], v[124:127], v[64:79]
  s_waitcnt lgkmcnt(5)
  v_mfma_f32_16x16x32_bf16 v[32:35], v[88:91], v[80:83], v[32:35]
  s_waitcnt lgkmcnt(3)
  v_mfma_f32_16x16x32_bf16 v[36:39], v[88:91], v[84:87], v[36:39]
  s_bitcmp1_b32 s40, 2
  s_cbranch_scc1 LB_first1
  s_bitcmp1_b32 s42, 1
  s_waitcnt vmcnt(8)
  s_mov_b64 exec, 1
  ds_inc_u32 v15, v15 offset:512
  s_mov_b64 exec, -1
  s_cbranch_scc1 LB_epi1
LB_done1:
  s_setprio 0
  v_exp_f32 v64, v64
  v_exp_f32 v65, v65
  v_exp_f32 v66, v66
  v_exp_f32 v67, v67
  v_exp_f32 v68, v68
  v_exp_f32 v69, v69
  v_exp_f32 v70, v70
  v_exp_f32 v71, v71
  v_exp_f32 v72, v72
  v_exp_f32 v73, v73
  v_exp_f32 v74, v74
  v_exp_f32 v75, v75
  v_exp_f32 v76, v76
  v_exp_f32 v77, v77
  v_exp_f32 v78, v78
  v_exp_f32 v79, v79
  v_add_f32 v64, 1.0, v64
  v_add_f32 v65, 1.0, v65
  v_add_f32 v66, 1.0, v66
  v_add_f32 v67, 1.0, v67
  v_add_f32 v68, 1.0, v68
  v_add_f32 v69, 1.0, v69
  v_add_f32 v70, 1.0, v70
  v_add_f32 v71, 1.0, v71
  s_setprio 2
  v_add_f32 v72, 1.0, v72
  v_add_f32 v73, 1.0, v73
  v_add_f32 v74, 1.0, v74
  v_add_f32 v75, 1.0, v75
  v_add_f32 v76, 1.0, v76
  v_add_f32 v77, 1.0, v77
  v_add_f32 v78, 1.0, v78
  v_add_f32 v79, 1.0, v79
  v_rcp_f32 v64, v64
  v_rcp_f32 v65, v65
  v_rcp_f32 v66, v66
  v_rcp_f32 v67, v67
  v_rcp_f32 v68, v68
  v_rcp_f32 v69, v69
  v_rcp_f32 v70, v70
  v_rcp_f32 v71, v71
  v_cvt_pk_bf16_f32 v64, v64, v65
  v_cvt_pk_bf16_f32 v65, v66, v67
  v_cvt_pk_bf16_f32 v66, v68, v69
  v_cvt_pk_bf16_f32 v67, v70, v71
  v_rcp_f32 v72, v72
  v_rcp_f32 v73, v73
  ds_read_b32 v21, v15 offset:512
  v_rcp_f32 v74, v74
  v_rcp_f32 v75, v75
  v_rcp_f32 v76, v76
  v_rcp_f32 v77, v77
  v_rcp_f32 v78, v78
  v_rcp_f32 v79, v79
  v_cvt_pk_bf16_f32 v68, v72, v73
  v_cvt_pk_bf16_f32 v69, v74, v75
  v_cvt_pk_bf16_f32 v70, v76, v77
  v_cvt_pk_bf16_f32 v71, v78, v79
LB_vj1:
  s_waitcnt lgkmcnt(0)
  v_readfirstlane_b32 s55, v21
  s_setprio 3
  s_cmp_ge_u32 s55, s93
  s_cbranch_scc0 LB_slow1
LB_b2:
  ds_read_b128 v[96:99], v0 offset:16384
  ds_read_b128 v[100:103], v1 offset:16384
  ds_read_b128 v[104:107], v2 offset:16384
  ds_read_b128 v[108:111], v3 offset:16384
  v_mfma_f32_16x16x32_bf16 v[28:31], v[40:43], v[64:67], v[22:25]
  ds_read_b128 v[112:115], v0 offset:20480
  ds_read_b128 v[116:119], v1 offset:20480
  v_mfma_f32_16x16x32_bf16 v[28:31], v[44:47], v[68:71], v[28:31]
  ds_read_b128 v[120:123], v2 offset:20480
  ds_read_b128 v[124:127], v3 offset:20480
  v_lshl_add_u32 v21, v9, 8, v10
  s_add_u32 m0, s37, 57344
  ds_read_b128 v[88:91], v15 offset:0
  buffer_load_dwordx4 v21, s[4:7], 0 offen nt lds
  s_waitcnt lgkmcnt(8)
  v_mfma_f32_32x32x16_bf16 v[64:79], v[224:227], v[96:99], v[48:63]
  v_mul_f32 v28, v28, v12
  v_mul_f32 v29, v29, v13
  v_cvt_pk_bf16_f32 v28, v28, v29
  ds_write_b32 v14, v28 offset:256
  s_waitcnt lgkmcnt(8)
  v_mfma_f32_32x32x16_bf16 v[64:79], v[228:231], v[100:103], v[64:79]
  s_add_u32 m0, s37, 61312
  ds_read_b64_tr_b16 v[80:81], v4 offset:0
  buffer_load_dwordx4 v21, s[4:7], 0 offen offset:128 nt lds
  ds_read_b64_tr_b16 v[82:83], v6 offset:0
  s_waitcnt lgkmcnt(9)
  v_mfma_f32_32x32x16_bf16 v[64:79], v[232:235], v[104:107], v[64:79]
  ds_read_b64_tr_b16 v[84:85], v5 offset:0
  ds_read_b64_tr_b16 v[86:87], v7 offset:0
  ds_read_u16 v9, v8 offset:512
  s_waitcnt lgkmcnt(11)
  v_mfma_f32_32x32x16_bf16 v[64:79], v[236:239], v[108:111], v[64:79]
  ds_read_u16_d16_hi v12, v11 offset:192
  ds_read_u16_d16_hi v13, v11 offset:224
  s_add_u32 s92, s92, 4
  s_bitcmp1_b32 s34, 2
  s_cselect_b32 s93, -1, s92
  s_waitcnt lgkmcnt(12)
  v_mfma_f32_32x32x16_bf16 v[64:79], v[240:243], v[112:115], v[64:79]
  s_waitcnt lgkmcnt(11)
  v_mfma_f32_32x32x16_bf16 v[64:79], v[244:247], v[116:119], v[64:79]
  s_waitcnt lgkmcnt(10)
  v_mfma_f32_32x32x16_bf16 v[64:79], v[248:251], v[120:123], v[64:79]
  s_waitcnt lgkmcnt(9)
  v_mfma_f32_32x32x16_bf16 v[64:79], v[252:255], v[124:127], v[64:79]
  s_waitcnt lgkmcnt(5)
  v_mfma_f32_16x16x32_bf16 v[32:35], v[88:91], v[80:83], v[32:35]
  s_waitcnt lgkmcnt(3)
  v_mfma_f32_16x16x32_bf16 v[36:39], v[88:91], v[84:87], v[36:39]
  s_bitcmp1_b32 s40, 3
  s_cbranch_scc1 LB_first2
  s_bitcmp1_b32 s42, 2
  s_waitcnt vmcnt(8)
  s_mov_b64 exec, 1
  ds_inc_u32 v15, v15 offset:512
  s_mov_b64 exec, -1
  s_cbranch_scc1 LB_epi2
LB_done2:
  s_setprio 0
  v_exp_f32 v64, v64
  v_exp_f32 v65, v65
  v_exp_f32 v66, v66
  v_exp_f32 v67, v67
  v_exp_f32 v68, v68
  v_exp_f32 v69, v69
  v_exp_f32 v70, v70
  v_exp_f32 v71, v71
  v_exp_f32 v72, v72
  v_exp_f32 v73, v73
  v_exp_f32 v74, v74
  v_exp_f32 v75, v75
  v_exp_f32 v76, v76
  v_exp_f32 v77, v77
  v_exp_f32 v78, v78
  v_exp_f32 v79, v79
  v_add_f32 v64, 1.0, v64
  v_add_f32 v65, 1.0, v65
  v_add_f32 v66, 1.0, v66
  v_add_f32 v67, 1.0, v67
  v_add_f32 v68, 1.0, v68
  v_add_f32 v69, 1.0, v69
  v_add_f32 v70, 1.0, v70
  v_add_f32 v71, 1.0, v71
  s_setprio 2
  v_add_f32 v72, 1.0, v72
  v_add_f32 v73, 1.0, v73
  v_add_f32 v74, 1.0, v74
  v_add_f32 v75, 1.0, v75
  v_add_f32 v76, 1.0, v76
  v_add_f32 v77, 1.0, v77
  v_add_f32 v78, 1.0, v78
  v_add_f32 v79, 1.0, v79
  v_rcp_f32 v64, v64
  v_rcp_f32 v65, v65
  v_rcp_f32 v66, v66
  v_rcp_f32 v67, v67
  v_rcp_f32 v68, v68
  v_rcp_f32 v69, v69
  v_rcp_f32 v70, v70
  v_rcp_f32 v71, v71
  v_cvt_pk_bf16_f32 v64, v64, v65
  v_cvt_pk_bf16_f32 v65, v66, v67
  v_cvt_pk_bf16_f32 v66, v68, v69
  v_cvt_pk_bf16_f32 v67, v70, v71
  v_rcp_f32 v72, v72
  v_rcp_f32 v73, v73
  ds_read_b32 v21, v15 offset:512
  v_rcp_f32 v74, v74
  v_rcp_f32 v75, v75
  v_rcp_f32 v76, v76
  v_rcp_f32 v77, v77
  v_rcp_f32 v78, v78
  v_rcp_f32 v79, v79
  v_cvt_pk_bf16_f32 v68, v72, v73
  v_cvt_pk_bf16_f32 v69, v74, v75
  v_cvt_pk_bf16_f32 v70, v76, v77
  v_cvt_pk_bf16_f32 v71, v78, v79
LB_vj2:
  s_waitcnt lgkmcnt(0)
  v_readfirstlane_b32 s55, v21
  s_setprio 3
  s_cmp_ge_u32 s55, s93
  s_cbranch_scc0 LB_slow2
LB_b3:
  ds_read_b128 v[96:99], v0 offset:24576
  ds_read_b128 v[100:103], v1 offset:24576
  ds_read_b128 v[104:107], v2 offset:24576
  ds_read_b128 v[108:111], v3 offset:24576
  v_mfma_f32_16x16x32_bf16 v[28:31], v[40:43], v[64:67], v[22:25]
  ds_read_b128 v[112:115], v0 offset:28672
  ds_read_b128 v[116:119], v1 offset:28672
  v_mfma_f32_16x16x32_bf16 v[28:31], v[44:47], v[68:71], v[28:31]
  ds_read_b128 v[120:123], v2 offset:28672
  ds_read_b128 v[124:127], v3 offset:28672
  v_lshl_add_u32 v21, v9, 8, v10
  s_add_u32 m0, s37, 0
  ds_read_b128 v[88:91], v15 offset:256
  buffer_load_dwordx4 v21, s[4:7], 0 offen nt lds
  s_waitcnt lgkmcnt(8)
  v_mfma_f32_32x32x16_bf16 v[64:79], v[224:227], v[96:99], v[48:63]
  v_mul_f32 v28, v28, v12
  v_mul_f32 v29, v29, v13
  v_cvt_pk_bf16_f32 v28, v28, v29
  ds_write_b32 v14, v28 offset:0
  s_waitcnt lgkmcnt(8)
  v_mfma_f32_32x32x16_bf16 v[64:79], v[228:231], v[100:103], v[64:79]
  s_add_u32 m0, s37, 3968
  ds_read_b64_tr_b16 v[80:81], v4 offset:8192
  buffer_load_dwordx4 v21, s[4:7], 0 offen offset:128 nt lds
  ds_read_b64_tr_b16 v[82:83], v6 offset:8192
  s_waitcnt lgkmcnt(9)
  v_mfma_f32_32x32x16_bf16 v[64:79], v[232:235], v[104:107], v[64:79]
  ds_read_b64_tr_b16 v[84:85], v5 offset:8192
  ds_read_b64_tr_b16 v[86:87], v7 offset:8192
  ds_read_u16 v9, v8 offset:576
  s_waitcnt lgkmcnt(11)
  v_mfma_f32_32x32x16_bf16 v[64:79], v[236:239], v[108:111], v[64:79]
  ds_read_u16_d16_hi v12, v11 offset:256
  ds_read_u16_d16_hi v13, v11 offset:288
  s_add_u32 s92, s92, 4
  s_bitcmp1_b32 s34, 3
  s_cselect_b32 s93, -1, s92
  s_waitcnt lgkmcnt(12)
  v_mfma_f32_32x32x16_bf16 v[64:79], v[240:243], v[112:115], v[64:79]
  s_waitcnt lgkmcnt(11)
  v_mfma_f32_32x32x16_bf16 v[64:79], v[244:247], v[116:119], v[64:79]
  s_waitcnt lgkmcnt(10)
  v_mfma_f32_32x32x16_bf16 v[64:79], v[248:251], v[120:123], v[64:79]
  s_waitcnt lgkmcnt(9)
  v_mfma_f32_32x32x16_bf16 v[64:79], v[252:255], v[124:127], v[64:79]
  s_waitcnt lgkmcnt(5)
  v_mfma_f32_16x16x32_bf16 v[32:35], v[88:91], v[80:83], v[32:35]
  s_waitcnt lgkmcnt(3)
  v_mfma_f32_16x16x32_bf16 v[36:39], v[88:91], v[84:87], v[36:39]
  s_bitcmp1_b32 s40, 4
  s_cbranch_scc1 LB_first3
  s_bitcmp1_b32 s42, 3
  s_waitcnt vmcnt(8)
  s_mov_b64 exec, 1
  ds_inc_u32 v15, v15 offset:512
  s_mov_b64 exec, -1
  s_cbranch_scc1 LB_epi3
LB_done3:
  s_setprio 0
  v_exp_f32 v64, v64
  v_exp_f32 v65, v65
  v_exp_f32 v66, v66
  v_exp_f32 v67, v67
  v_exp_f32 v68, v68
  v_exp_f32 v69, v69
  v_exp_f32 v70, v70
  v_exp_f32 v71, v71
  v_exp_f32 v72, v72
  v_exp_f32 v73, v73
  v_exp_f32 v74, v74
  v_exp_f32 v75, v75
  v_exp_f32 v76, v76
  v_exp_f32 v77, v77
  v_exp_f32 v78, v78
  v_exp_f32 v79, v79
  v_add_f32 v64, 1.0, v64
  v_add_f32 v65, 1.0, v65
  v_add_f32 v66, 1.0, v66
  v_add_f32 v67, 1.0, v67
  v_add_f32 v68, 1.0, v68
  v_add_f32 v69, 1.0, v69
  v_add_f32 v70, 1.0, v70
  v_add_f32 v71, 1.0, v71
  s_setprio 2
  v_add_f32 v72, 1.0, v72
  v_add_f32 v73, 1.0, v73
  v_add_f32 v74, 1.0, v74
  v_add_f32 v75, 1.0, v75
  v_add_f32 v76, 1.0, v76
  v_add_f32 v77, 1.0, v77
  v_add_f32 v78, 1.0, v78
  v_add_f32 v79, 1.0, v79
  v_rcp_f32 v64, v64
  v_rcp_f32 v65, v65
  v_rcp_f32 v66, v66
  v_rcp_f32 v67, v67
  v_rcp_f32 v68, v68
  v_rcp_f32 v69, v69
  v_rcp_f32 v70, v70
  v_rcp_f32 v71, v71
  v_cvt_pk_bf16_f32 v64, v64, v65
  v_cvt_pk_bf16_f32 v65, v66, v67
  v_cvt_pk_bf16_f32 v66, v68, v69
  v_cvt_pk_bf16_f32 v67, v70, v71
  v_rcp_f32 v72, v72
  v_rcp_f32 v73, v73
  ds_read_b32 v21, v15 offset:512
  v_rcp_f32 v74, v74
  v_rcp_f32 v75, v75
  v_rcp_f32 v76, v76
  v_rcp_f32 v77, v77
  v_rcp_f32 v78, v78
  v_rcp_f32 v79, v79
  v_cvt_pk_bf16_f32 v68, v72, v73
  v_cvt_pk_bf16_f32 v69, v74, v75
  v_cvt_pk_bf16_f32 v70, v76, v77
  v_cvt_pk_bf16_f32 v71, v78, v79
LB_vj3:
  s_waitcnt lgkmcnt(0)
  v_readfirstlane_b32 s55, v21
  s_setprio 3
  s_cmp_ge_u32 s55, s93
  s_cbranch_scc0 LB_slow3
LB_b4:
  ds_read_b128 v[96:99], v0 offset:32768
  ds_read_b128 v[100:103], v1 offset:32768
  ds_read_b128 v[104:107], v2 offset:32768
  ds_read_b128 v[108:111], v3 offset:32768
  v_mfma_f32_16x16x32_bf16 v[28:31], v[40:43], v[64:67], v[22:25]
  ds_read_b128 v[112:115], v0 offset:36864
  ds_read_b128 v[116:119], v1 offset:36864
  v_mfma_f32_16x16x32_bf16 v[28:31], v[44:47], v[68:71], v[28:31]
  ds_read_b128 v[120:123], v2 offset:36864
  ds_read_b128 v[124:127], v3 offset:36864
  v_lshl_add_u32 v21, v9, 8, v10
  s_add_u32 m0, s37, 8192
  ds_read_b128 v[88:91], v15 offset:0
  buffer_load_dwordx4 v21, s[4:7], 0 offen nt lds
  s_waitcnt lgkmcnt(8)
  v_mfma_f32_32x32x16_bf16 v[64:79], v[224:227], v[96:99], v[48:63]
  v_mul_f32 v28, v28, v12
  v_mul_f32 v29, v29, v13
  v_cvt_pk_bf16_f32 v28, v28, v29
  ds_write_b32 v14, v28 offset:256
  s_waitcnt lgkmcnt(8)
  v_mfma_f32_32x32x16_bf16 v[64:79], v[228:231], v[100:103], v[64:79]
  s_add_u32 m0, s37, 12160
  ds_read_b64_tr_b16 v[80:81], v4 offset:16384
  buffer_load_dwordx4 v21, s[4:7], 0 offen offset:128 nt lds
  ds_read_b64_tr_b16 v[82:83], v6 offset:16384
  s_waitcnt lgkmcnt(9)
  v_mfma_f32_32x32x16_bf16 v[64:79], v[232:235], v[104:107], v[64:79]
  ds_read_b64_tr_b16 v[84:85], v5 offset:16384
  ds_read_b64_tr_b16 v[86:87], v7 offset:16384
  ds_read_u16 v9, v8 offset:640
  s_waitcnt lgkmcnt(11)
  v_mfma_f32_32x32x16_bf16 v[64:79], v[236:239], v[108:111], v[64:79]
  ds_read_u16_d16_hi v12, v11 offset:320
  ds_read_u16_d16_hi v13, v11 offset:352
  s_add_u32 s92, s92, 4
  s_bitcmp1_b32 s34, 4
  s_cselect_b32 s93, -1, s92
  s_waitcnt lgkmcnt(12)
  v_mfma_f32_32x32x16_bf16 v[64:79], v[240:243], v[112:115], v[64:79]
  s_waitcnt lgkmcnt(11)
  v_mfma_f32_32x32x16_bf16 v[64:79], v[244:247], v[116:119], v[64:79]
  s_waitcnt lgkmcnt(10)
  v_mfma_f32_32x32x16_bf16 v[64:79], v[248:251], v[120:123], v[64:79]
  s_waitcnt lgkmcnt(9)
  v_mfma_f32_32x32x16_bf16 v[64:79], v[252:255], v[124:127], v[64:79]
  s_waitcnt lgkmcnt(5)
  v_mfma_f32_16x16x32_bf16 v[32:35], v[88:91], v[80:83], v[32:35]
  s_waitcnt lgkmcnt(3)
  v_mfma_f32_16x16x32_bf16 v[36:39], v[88:91], v[84:87], v[36:39]
  s_bitcmp1_b32 s40, 5
  s_cbranch_scc1 LB_first4
  s_bitcmp1_b32 s42, 4
  s_waitcnt vmcnt(8)
  s_mov_b64 exec, 1
  ds_inc_u32 v15, v15 offset:512
  s_mov_b64 exec, -1
  s_cbranch_scc1 LB_epi4
LB_done4:
  s_setprio 0
  v_exp_f32 v64, v64
  v_exp_f32 v65, v65
  v_exp_f32 v66, v66
  v_exp_f32 v67, v67
  v_exp_f32 v68, v68
  v_exp_f32 v69, v69
  v_exp_f32 v70, v70
  v_exp_f32 v71, v71
  v_exp_f32 v72, v72
  v_exp_f32 v73, v73
  v_exp_f32 v74, v74
  v_exp_f32 v75, v75
  v_exp_f32 v76, v76
  v_exp_f32 v77, v77
  v_exp_f32 v78, v78
  v_exp_f32 v79, v79
  v_add_f32 v64, 1.0, v64
  v_add_f32 v65, 1.0, v65
  v_add_f32 v66, 1.0, v66
  v_add_f32 v67, 1.0, v67
  v_add_f32 v68, 1.0, v68
  v_add_f32 v69, 1.0, v69
  v_add_f32 v70, 1.0, v70
  v_add_f32 v71, 1.0, v71
  s_setprio 2
  v_add_f32 v72, 1.0, v72
  v_add_f32 v73, 1.0, v73
  v_add_f32 v74, 1.0, v74
  v_add_f32 v75, 1.0, v75
  v_add_f32 v76, 1.0, v76
  v_add_f32 v77, 1.0, v77
  v_add_f32 v78, 1.0, v78
  v_add_f32 v79, 1.0, v79
  v_rcp_f32 v64, v64
  v_rcp_f32 v65, v65
  v_rcp_f32 v66, v66
  v_rcp_f32 v67, v67
  v_rcp_f32 v68, v68
  v_rcp_f32 v69, v69
  v_rcp_f32 v70, v70
  v_rcp_f32 v71, v71
  v_cvt_pk_bf16_f32 v64, v64, v65
  v_cvt_pk_bf16_f32 v65, v66, v67
  v_cvt_pk_bf16_f32 v66, v68, v69
  v_cvt_pk_bf16_f32 v67, v70, v71
  v_rcp_f32 v72, v72
  v_rcp_f32 v73, v73
  ds_read_b32 v21, v15 offset:512
  v_rcp_f32 v74, v74
  v_rcp_f32 v75, v75
  v_rcp_f32 v76, v76
  v_rcp_f32 v77, v77
  v_rcp_f32 v78, v78
  v_rcp_f32 v79, v79
  v_cvt_pk_bf16_f32 v68, v72, v73
  v_cvt_pk_bf16_f32 v69, v74, v75
  v_cvt_pk_bf16_f32 v70, v76, v77
  v_cvt_pk_bf16_f32 v71, v78, v79
LB_vj4:
  s_waitcnt lgkmcnt(0)
  v_readfirstlane_b32 s55, v21
  s_setprio 3
  s_cmp_ge_u32 s55, s93
  s_cbranch_scc0 LB_slow4
LB_b5:
  ds_read_b128 v[96:99], v0 offset:40960
  ds_read_b128 v[100:103], v1 offset:40960
  ds_read_b128 v[104:107], v2 offset:40960
  ds_read_b128 v[108:111], v3 offset:40960
  v_mfma_f32_16x16x32_bf16 v[28:31], v[40:43], v[64:67], v[22:25]
  ds_read_b128 v[112:115], v0 offset:45056
  ds_read_b128 v[116:119], v1 offset:45056
  v_mfma_f32_16x16x32_bf16 v[28:31], v[44:47], v[68:71], v[28:31]
  ds_read_b128 v[120:123], v2 offset:45056
  ds_read_b128 v[124:127], v3 offset:45056
  v_lshl_add_u32 v21, v9, 8, v10
  s_add_u32 m0, s37, 16384
  ds_read_b128 v[88:91], v15 offset:256
  buffer_load_dwordx4 v21, s[4:7], 0 offen nt lds
  s_waitcnt lgkmcnt(8)
  v_mfma_f32_32x32x16_bf16 v[64:79], v[224:227], v[96:99], v[48:63]
  v_mul_f32 v28, v28, v12
  v_mul_f32 v29, v29, v13
  v_cvt_pk_bf16_f32 v28, v28, v29
  ds_write_b32 v14, v28 offset:0
  s_waitcnt lgkmcnt(8)
  v_mfma_f32_32x32x16_bf16 v[64:79], v[228:231], v[100:103], v[64:79]
  s_add_u32 m0, s37, 20352
  ds_read_b64_tr_b16 v[80:81], v4 offset:24576
  buffer_load_dwordx4 v21, s[4:7], 0 offen offset:128 nt lds
  ds_read_b64_tr_b16 v[82:83], v6 offset:24576
  s_waitcnt lgkmcnt(9)
  v_mfma_f32_32x32x16_bf16 v[64:79], v[232:235], v[104:107], v[64:79]
  ds_read_b64_tr_b16 v[84:85], v5 offset:24576
  ds_read_b64_tr_b16 v[86:87], v7 offset:24576
  ds_read_u16 v9, v8 offset:704
  s_waitcnt lgkmcnt(11)
  v_mfma_f32_32x32x16_bf16 v[64:79], v[236:239], v[108:111], v[64:79]
  ds_read_u16_d16_hi v12, v11 offset:384
  ds_read_u16_d16_hi v13, v11 offset:416
  s_add_u32 s92, s92, 4
  s_bitcmp1_b32 s34, 5
  s_cselect_b32 s93, -1, s92
  s_waitcnt lgkmcnt(12)
  v_mfma_f32_32x32x16_bf16 v[64:79], v[240:243], v[112:115], v[64:79]
  s_waitcnt lgkmcnt(11)
  v_mfma_f32_32x32x16_bf16 v[64:79], v[244:247], v[116:119], v[64:79]
  s_waitcnt lgkmcnt(10)
  v_mfma_f32_32x32x16_bf16 v[64:79], v[248:251], v[120:123], v[64:79]
  s_waitcnt lgkmcnt(9)
  v_mfma_f32_32x32x16_bf16 v[64:79], v[252:255], v[124:127], v[64:79]
  s_waitcnt lgkmcnt(5)
  v_mfma_f32_16x16x32_bf16 v[32:35], v[88:91], v[80:83], v[32:35]
  s_waitcnt lgkmcnt(3)
  v_mfma_f32_16x16x32_bf16 v[36:39], v[88:91], v[84:87], v[36:39]
  s_bitcmp1_b32 s40, 6
  s_cbranch_scc1 LB_first5
  s_bitcmp1_b32 s42, 5
  s_waitcnt vmcnt(8)
  s_mov_b64 exec, 1
  ds_inc_u32 v15, v15 offset:512
  s_mov_b64 exec, -1
  s_cbranch_scc1 LB_epi5
LB_done5:
  s_setprio 0
  v_exp_f32 v64, v64
  v_exp_f32 v65, v65
  v_exp_f32 v66, v66
  v_exp_f32 v67, v67
  v_exp_f32 v68, v68
  v_exp_f32 v69, v69
  v_exp_f32 v70, v70
  v_exp_f32 v71, v71
  v_exp_f32 v72, v72
  v_exp_f32 v73, v73
  v_exp_f32 v74, v74
  v_exp_f32 v75, v75
  v_exp_f32 v76, v76
  v_exp_f32 v77, v77
  v_exp_f32 v78, v78
  v_exp_f32 v79, v79
  v_add_f32 v64, 1.0, v64
  v_add_f32 v65, 1.0, v65
  v_add_f32 v66, 1.0, v66
  v_add_f32 v67, 1.0, v67
  v_add_f32 v68, 1.0, v68
  v_add_f32 v69, 1.0, v69
  v_add_f32 v70, 1.0, v70
  v_add_f32 v71, 1.0, v71
  s_setprio 2
  v_add_f32 v72, 1.0, v72
  v_add_f32 v73, 1.0, v73
  v_add_f32 v74, 1.0, v74
  v_add_f32 v75, 1.0, v75
  v_add_f32 v76, 1.0, v76
  v_add_f32 v77, 1.0, v77
  v_add_f32 v78, 1.0, v78
  v_add_f32 v79, 1.0, v79
  v_rcp_f32 v64, v64
  v_rcp_f32 v65, v65
  v_rcp_f32 v66, v66
  v_rcp_f32 v67, v67
  v_rcp_f32 v68, v68
  v_rcp_f32 v69, v69
  v_rcp_f32 v70, v70
  v_rcp_f32 v71, v71
  v_cvt_pk_bf16_f32 v64, v64, v65
  v_cvt_pk_bf16_f32 v65, v66, v67
  v_cvt_pk_bf16_f32 v66, v68, v69
  v_cvt_pk_bf16_f32 v67, v70, v71
  v_rcp_f32 v72, v72
  v_rcp_f32 v73, v73
  ds_read_b32 v21, v15 offset:512
  v_rcp_f32 v74, v74
  v_rcp_f32 v75, v75
  v_rcp_f32 v76, v76
  v_rcp_f32 v77, v77
  v_rcp_f32 v78, v78
  v_rcp_f32 v79, v79
  v_cvt_pk_bf16_f32 v68, v72, v73
  v_cvt_pk_bf16_f32 v69, v74, v75
  v_cvt_pk_bf16_f32 v70, v76, v77
  v_cvt_pk_bf16_f32 v71, v78, v79
LB_vj5:
  s_waitcnt lgkmcnt(0)
  v_readfirstlane_b32 s55, v21
  s_setprio 3
  s_cmp_ge_u32 s55, s93
  s_cbranch_scc0 LB_slow5
LB_b6:
  ds_read_b128 v[96:99], v0 offset:49152
  ds_read_b128 v[100:103], v1 offset:49152
  ds_read_b128 v[104:107], v2 offset:49152
  ds_read_b128 v[108:111], v3 offset:49152
  v_mfma_f32_16x16x32_bf16 v[28:31], v[40:43], v[64:67], v[22:25]
  ds_read_b128 v[112:115], v0 offset:53248
  ds_read_b128 v[116:119], v1 offset:53248
  v_mfma_f32_16x16x32_bf16 v[28:31], v[44:47], v[68:71], v[28:31]
  ds_read_b128 v[120:123], v2 offset:53248
  ds_read_b128 v[124:127], v3 offset:53248
  v_lshl_add_u32 v21, v9, 8, v10
  s_add_u32 m0, s37, 24576
  ds_read_b128 v[88:91], v15 offset:0
  buffer_load_dwordx4 v21, s[4:7], 0 offen nt lds
  s_waitcnt lgkmcnt(8)
  v_mfma_f32_32x32x16_bf16 v[64:79], v[224:227], v[96:99], v[48:63]
  v_mul_f32 v28, v28, v12
  v_mul_f32 v29, v29, v13
  v_cvt_pk_bf16_f32 v28, v28, v29
  ds_write_b32 v14, v28 offset:256
  s_waitcnt lgkmcnt(8)
  v_mfma_f32_32x32x16_bf16 v[64:79], v[228:231], v[100:103], v[64:79]
  s_add_u32 m0, s37, 28544
  ds_read_b64_tr_b16 v[80:81], v4 offset:32768
  buffer_load_dwordx4 v21, s[4:7], 0 offen offset:128 nt lds
  ds_read_b64_tr_b16 v[82:83], v6 offset:32768
  s_waitcnt lgkmcnt(9)
  v_mfma_f32_32x32x16_bf16 v[64:79], v[232:235], v[104:107], v[64:79]
  ds_read_b64_tr_b16 v[84:85], v5 offset:32768
  ds_read_b64_tr_b16 v[86:87], v7 offset:32768
  ds_read_u16 v9, v8 offset:768
  s_waitcnt lgkmcnt(11)
  v_mfma_f32_32x32x16_bf16 v[64:79], v[236:239], v[108:111], v[64:79]
  ds_read_u16_d16_hi v12, v11 offset:448
  ds_read_u16_d16_hi v13, v11 offset:480
  s_add_u32 s92, s92, 4
  s_bitcmp1_b32 s34, 6
  s_cselect_b32 s93, -1, s92
  s_waitcnt lgkmcnt(12)
  v_mfma_f32_32x32x16_bf16 v[64:79], v[240:243], v[112:115], v[64:79]
  s_waitcnt lgkmcnt(11)
  v_mfma_f32_32x32x16_bf16 v[64:79], v[244:247], v[116:119], v[64:79]
  s_waitcnt lgkmcnt(10)
  v_mfma_f32_32x32x16_bf16 v[64:79], v[248:251], v[120:123], v[64:79]
  s_waitcnt lgkmcnt(9)
  v_mfma_f32_32x32x16_bf16 v[64:79], v[252:255], v[124:127], v[64:79]
  s_waitcnt lgkmcnt(5)
  v_mfma_f32_16x16x32_bf16 v[32:35], v[88:91], v[80:83], v[32:35]
  s_waitcnt lgkmcnt(3)
  v_mfma_f32_16x16x32_bf16 v[36:39], v[88:91], v[84:87], v[36:39]
  s_bitcmp1_b32 s40, 7
  s_cbranch_scc1 LB_first6
  s_bitcmp1_b32 s42, 6
  s_waitcnt vmcnt(8)
  s_mov_b64 exec, 1
  ds_inc_u32 v15, v15 offset:512
  s_mov_b64 exec, -1
  s_cbranch_scc1 LB_epi6
LB_done6:
  s_setprio 0
  v_exp_f32 v64, v64
  v_exp_f32 v65, v65
  v_exp_f32 v66, v66
  v_exp_f32 v67, v67
  v_exp_f32 v68, v68
  v_exp_f32 v69, v69
  v_exp_f32 v70, v70
  v_exp_f32 v71, v71
  v_exp_f32 v72, v72
  v_exp_f32 v73, v73
  v_exp_f32 v74, v74
  v_exp_f32 v75, v75
  v_exp_f32 v76, v76
  v_exp_f32 v77, v77
  v_exp_f32 v78, v78
  v_exp_f32 v79, v79
  v_add_f32 v64, 1.0, v64
  v_add_f32 v65, 1.0, v65
  v_add_f32 v66, 1.0, v66
  v_add_f32 v67, 1.0, v67
  v_add_f32 v68, 1.0, v68
  v_add_f32 v69, 1.0, v69
  v_add_f32 v70, 1.0, v70
  v_add_f32 v71, 1.0, v71
  s_setprio 2
  v_add_f32 v72, 1.0, v72
  v_add_f32 v73, 1.0, v73
  v_add_f32 v74, 1.0, v74
  v_add_f32 v75, 1.0, v75
  v_add_f32 v76, 1.0, v76
  v_add_f32 v77, 1.0, v77
  v_add_f32 v78, 1.0, v78
  v_add_f32 v79, 1.0, v79
  v_rcp_f32 v64, v64
  v_rcp_f32 v65, v65
  v_rcp_f32 v66, v66
  v_rcp_f32 v67, v67
  v_rcp_f32 v68, v68
  v_rcp_f32 v69, v69
  v_rcp_f32 v70, v70
  v_rcp_f32 v71, v71
  v_cvt_pk_bf16_f32 v64, v64, v65
  v_cvt_pk_bf16_f32 v65, v66, v67
  v_cvt_pk_bf16_f32 v66, v68, v69
  v_cvt_pk_bf16_f32 v67, v70, v71
  v_rcp_f32 v72, v72
  v_rcp_f32 v73, v73
  ds_read_b32 v21, v15 offset:512
  v_rcp_f32 v74, v74
  v_rcp_f32 v75, v75
  v_rcp_f32 v76, v76
  v_rcp_f32 v77, v77
  v_rcp_f32 v78, v78
  v_rcp_f32 v79, v79
  v_cvt_pk_bf16_f32 v68, v72, v73
  v_cvt_pk_bf16_f32 v69, v74, v75
  v_cvt_pk_bf16_f32 v70, v76, v77
  v_cvt_pk_bf16_f32 v71, v78, v79
LB_vj6:
  s_waitcnt lgkmcnt(0)
  v_readfirstlane_b32 s55, v21
  s_setprio 3
  s_cmp_ge_u32 s55, s93
  s_cbranch_scc0 LB_slow6
LB_b7:
  ds_read_b128 v[96:99], v0 offset:57344
  ds_read_b128 v[100:103], v1 offset:57344
  ds_read_b128 v[104:107], v2 offset:57344
  ds_read_b128 v[108:111], v3 offset:57344
  v_mfma_f32_16x16x32_bf16 v[28:31], v[40:43], v[64:67], v[22:25]
  ds_read_b128 v[112:115], v0 offset:61440
  ds_read_b128 v[116:119], v1 offset:61440
  v_mfma_f32_16x16x32_bf16 v[28:31], v[44:47], v[68:71], v[28:31]
  ds_read_b128 v[120:123], v2 offset:61440
  ds_read_b128 v[124:127], v3 offset:61440
  v_lshl_add_u32 v21, v9, 8, v10
  s_add_u32 m0, s37, 32768
  ds_read_b128 v[88:91], v15 offset:256
  buffer_load_dwordx4 v21, s[4:7], 0 offen nt lds
  s_waitcnt lgkmcnt(8)
  v_mfma_f32_32x32x16_bf16 v[64:79], v[224:227], v[96:99], v[48:63]
  v_mul_f32 v28, v28, v12
  v_mul_f32 v29, v29, v13
  v_cvt_pk_bf16_f32 v28, v28, v29
  ds_write_b32 v14, v28 offset:0
  s_waitcnt lgkmcnt(8)
  v_mfma_f32_32x32x16_bf16 v[64:79], v[228:231], v[100:103], v[64:79]
  s_add_u32 m0, s37, 36736
  ds_read_b64_tr_b16 v[80:81], v4 offset:40960
  buffer_load_dwordx4 v21, s[4:7], 0 offen offset:128 nt lds
  ds_read_b64_tr_b16 v[82:83], v6 offset:40960
  s_waitcnt lgkmcnt(9)
  v_mfma_f32_32x32x16_bf16 v[64:79], v[232:235], v[104:107], v[64:79]
  ds_read_b64_tr_b16 v[84:85], v5 offset:40960
  ds_read_b64_tr_b16 v[86:87], v7 offset:40960
  ds_read_u16 v9, v8 offset:832
  s_waitcnt lgkmcnt(11)
  v_mfma_f32_32x32x16_bf16 v[64:79], v[236:239], v[108:111], v[64:79]
  ds_read_u16_d16_hi v12, v11 offset:512
  ds_read_u16_d16_hi v13, v11 offset:544
  s_add_u32 s92, s92, 4
  s_bitcmp1_b32 s34, 7
  s_cselect_b32 s93, -1, s92
  s_waitcnt lgkmcnt(12)
  v_mfma_f32_32x32x16_bf16 v[64:79], v[240:243], v[112:115], v[64:79]
  s_waitcnt lgkmcnt(11)
  v_mfma_f32_32x32x16_bf16 v[64:79], v[244:247], v[116:119], v[64:79]
  s_waitcnt lgkmcnt(10)
  v_mfma_f32_32x32x16_bf16 v[64:79], v[248:251], v[120:123], v[64:79]
  s_waitcnt lgkmcnt(9)
  v_mfma_f32_32x32x16_bf16 v[64:79], v[252:255], v[124:127], v[64:79]
  s_waitcnt lgkmcnt(5)
  v_mfma_f32_16x16x32_bf16 v[32:35], v[88:91], v[80:83], v[32:35]
  s_waitcnt lgkmcnt(3)
  v_mfma_f32_16x16x32_bf16 v[36:39], v[88:91], v[84:87], v[36:39]
  s_bitcmp1_b32 s40, 8
  s_cbranch_scc1 LB_first7
  s_bitcmp1_b32 s42, 7
  s_waitcnt vmcnt(8)
  s_mov_b64 exec, 1
  ds_inc_u32 v15, v15 offset:512
  s_mov_b64 exec, -1
  s_cbranch_scc1 LB_epi7
LB_done7:
  s_setprio 0
  v_exp_f32 v64, v64
  v_exp_f32 v65, v65
  v_exp_f32 v66, v66
  v_exp_f32 v67, v67
  v_exp_f32 v68, v68
  v_exp_f32 v69, v69
  v_exp_f32 v70, v70
  v_exp_f32 v71, v71
  v_exp_f32 v72, v72
  v_exp_f32 v73, v73
  v_exp_f32 v74, v74
  v_exp_f32 v75, v75
  v_exp_f32 v76, v76
  v_exp_f32 v77, v77
  v_exp_f32 v78, v78
  v_exp_f32 v79, v79
  v_add_f32 v64, 1.0, v64
  v_add_f32 v65, 1.0, v65
  v_add_f32 v66, 1.0, v66
  v_add_f32 v67, 1.0, v67
  v_add_f32 v68, 1.0, v68
  v_add_f32 v69, 1.0, v69
  v_add_f32 v70, 1.0, v70
  v_add_f32 v71, 1.0, v71
  s_setprio 2
  v_add_f32 v72, 1.0, v72
  v_add_f32 v73, 1.0, v73
  v_add_f32 v74, 1.0, v74
  v_add_f32 v75, 1.0, v75
  v_add_f32 v76, 1.0, v76
  v_add_f32 v77, 1.0, v77
  v_add_f32 v78, 1.0, v78
  v_add_f32 v79, 1.0, v79
  v_rcp_f32 v64, v64
  v_rcp_f32 v65, v65
  v_rcp_f32 v66, v66
  v_rcp_f32 v67, v67
  v_rcp_f32 v68, v68
  v_rcp_f32 v69, v69
  v_rcp_f32 v70, v70
  v_rcp_f32 v71, v71
  v_cvt_pk_bf16_f32 v64, v64, v65
  v_cvt_pk_bf16_f32 v65, v66, v67
  v_cvt_pk_bf16_f32 v66, v68, v69
  v_cvt_pk_bf16_f32 v67, v70, v71
  v_rcp_f32 v72, v72
  v_rcp_f32 v73, v73
  ds_read_b32 v21, v15 offset:512
  v_rcp_f32 v74, v74
  v_rcp_f32 v75, v75
  v_rcp_f32 v76, v76
  v_rcp_f32 v77, v77
  v_rcp_f32 v78, v78
  v_rcp_f32 v79, v79
  v_cvt_pk_bf16_f32 v68, v72, v73
  v_cvt_pk_bf16_f32 v69, v74, v75
  v_cvt_pk_bf16_f32 v70, v76, v77
  v_cvt_pk_bf16_f32 v71, v78, v79
LB_vj7:
  v_add_u32 v8, 512, v8
  v_add_u32 v11, 512, v11
  s_lshr_b64 s[40:41], s[40:41], 8
  s_lshr_b64 s[42:43], s[42:43], 8
  s_lshr_b64 s[34:35], s[34:35], 8
  s_waitcnt lgkmcnt(0)
  v_readfirstlane_b32 s55, v21
  s_setprio 3
  s_cmp_ge_u32 s55, s93
  s_cbranch_scc0 LB_slow7
  s_branch LB_b0
LB_first0:
  ds_read_b128 v[80:83], v16 offset:0
  ds_read_b128 v[84:87], v17 offset:0
  ds_read_b128 v[88:91], v16 offset:528
  ds_read_b128 v[92:95], v17 offset:528
  ds_write_b16 v18, v24
  s_bitcmp1_b32 s42, 0
  s_waitcnt vmcnt(8)
  s_mov_b64 exec, 1
  ds_inc_u32 v15, v15 offset:512
  s_mov_b64 exec, -1
  ds_read_b128 v[48:51], v16 offset:1056
  ds_read_b128 v[52:55], v17 offset:1056
  ds_read_b128 v[56:59], v16 offset:1584
  ds_read_b128 v[60:63], v17 offset:1584
  s_cbranch_scc1 LB_fepi0
LB_fdone0:
  s_setprio 0
  v_exp_f32 v64, v64
  v_exp_f32 v65, v65
  s_waitcnt lgkmcnt(4)
  v_mfma_f32_32x32x16_bf16 v[96:111], v[80:83], v[192:195], v[128:143]
  v_exp_f32 v66, v66
  v_exp_f32 v67, v67
  v_exp_f32 v68, v68
  v_mfma_f32_32x32x16_bf16 v[96:111], v[84:87], v[196:199], v[96:111]
  v_exp_f32 v69, v69
  v_exp_f32 v70, v70
  v_exp_f32 v71, v71
  v_mfma_f32_32x32x16_bf16 v[112:127], v[88:91], v[200:203], v[144:159]
  v_exp_f32 v72, v72
  v_exp_f32 v73, v73
  v_exp_f32 v74, v74
  v_mfma_f32_32x32x16_bf16 v[112:127], v[92:95], v[204:207], v[112:127]
  v_exp_f32 v75, v75
  v_exp_f32 v76, v76
  v_exp_f32 v77, v77
  v_exp_f32 v78, v78
  v_exp_f32 v79, v79
  v_add_f32 v64, 1.0, v64
  v_add_f32 v65, 1.0, v65
  v_add_f32 v66, 1.0, v66
  s_setprio 2
  v_add_f32 v67, 1.0, v67
  v_add_f32 v68, 1.0, v68
  v_add_f32 v69, 1.0, v69
  v_add_f32 v70, 1.0, v70
  v_add_f32 v71, 1.0, v71
  v_add_f32 v72, 1.0, v72
  v_add_f32 v73, 1.0, v73
  v_add_f32 v74, 1.0, v74
  v_add_f32 v75, 1.0, v75
  v_add_f32 v76, 1.0, v76
  v_add_f32 v77, 1.0, v77
  v_add_f32 v78, 1.0, v78
  v_add_f32 v79, 1.0, v79
  v_cvt_pk_bf16_f32 v224, v96, v97
  v_cvt_pk_bf16_f32 v225, v98, v99
  v_cvt_pk_bf16_f32 v226, v100, v101
  v_cvt_pk_bf16_f32 v227, v102, v103
  v_cvt_pk_bf16_f32 v228, v104, v105
  v_cvt_pk_bf16_f32 v229, v106, v107
  v_cvt_pk_bf16_f32 v230, v108, v109
  v_cvt_pk_bf16_f32 v231, v110, v111
  v_cvt_pk_bf16_f32 v232, v112, v113
  v_cvt_pk_bf16_f32 v233, v114, v115
  v_cvt_pk_bf16_f32 v234, v116, v117
  v_cvt_pk_bf16_f32 v235, v118, v119
  v_cvt_pk_bf16_f32 v236, v120, v121
  v_cvt_pk_bf16_f32 v237, v122, v123
  v_cvt_pk_bf16_f32 v238, v124, v125
  v_cvt_pk_bf16_f32 v239, v126, v127
  v_rcp_f32 v64, v64
  v_rcp_f32 v65, v65
  v_rcp_f32 v66, v66
  v_rcp_f32 v67, v67
  v_rcp_f32 v68, v68
  v_rcp_f32 v69, v69
  v_rcp_f32 v70, v70
  v_rcp_f32 v71, v71
  v_cvt_pk_bf16_f32 v64, v64, v65
  v_cvt_pk_bf16_f32 v65, v66, v67
  v_cvt_pk_bf16_f32 v66, v68, v69
  v_cvt_pk_bf16_f32 v67, v70, v71
  s_waitcnt lgkmcnt(0)
  v_mfma_f32_32x32x16_bf16 v[96:111], v[48:51], v[208:211], v[160:175]
  v_rcp_f32 v72, v72
  v_rcp_f32 v73, v73
  v_rcp_f32 v74, v74
  v_mfma_f32_32x32x16_bf16 v[96:111], v[52:55], v[212:215], v[96:111]
  v_rcp_f32 v75, v75
  v_rcp_f32 v76, v76
  v_rcp_f32 v77, v77
  v_mfma_f32_32x32x16_bf16 v[112:127], v[56:59], v[216:219], v[176:191]
  v_rcp_f32 v78, v78
  v_rcp_f32 v79, v79
  v_mfma_f32_32x32x16_bf16 v[112:127], v[60:63], v[220:223], v[112:127]
  ds_read_b128 v[48:51], v19 offset:0
  ds_read_b128 v[52:55], v19 offset:32
  ds_read_b128 v[56:59], v19 offset:64
  ds_read_b128 v[60:63], v19 offset:96
  v_cvt_pk_bf16_f32 v68, v72, v73
  v_cvt_pk_bf16_f32 v69, v74, v75
  v_cvt_pk_bf16_f32 v70, v76, v77
  v_cvt_pk_bf16_f32 v71, v78, v79
  v_alignbit_b32 v24, v25, v24, 16
  v_alignbit_b32 v25, v26, v25, 16
  v_alignbit_b32 v26, v27, v26, 16
  v_lshrrev_b32 v27, 16, v27
  v_add_u32 v19, 0x200, v19
  v_add_u32 v16, s44, v16
  v_add_u32 v17, s44, v17
  s_sub_u32 s44, 0, s44
  v_add_u32 v18, s44, v18
  v_cvt_pk_bf16_f32 v240, v96, v97
  v_cvt_pk_bf16_f32 v241, v98, v99
  v_cvt_pk_bf16_f32 v242, v100, v101
  v_cvt_pk_bf16_f32 v243, v102, v103
  v_cvt_pk_bf16_f32 v244, v104, v105
  v_cvt_pk_bf16_f32 v245, v106, v107
  ds_read_b32 v21, v15 offset:512
  v_cvt_pk_bf16_f32 v246, v108, v109
  v_cvt_pk_bf16_f32 v247, v110, v111
  v_cvt_pk_bf16_f32 v248, v112, v113
  v_cvt_pk_bf16_f32 v249, v114, v115
  v_cvt_pk_bf16_f32 v250, v116, v117
  v_cvt_pk_bf16_f32 v251, v118, v119
  v_cvt_pk_bf16_f32 v252, v120, v121
  v_cvt_pk_bf16_f32 v253, v122, v123
  v_cvt_pk_bf16_f32 v254, v124, v125
  v_cvt_pk_bf16_f32 v255, v126, v127
  s_branch LB_vj0
LB_first1:
  ds_read_b128 v[80:83], v16 offset:0
  ds_read_b128 v[84:87], v17 offset:0
  ds_read_b128 v[88:91], v16 offset:528
  ds_read_b128 v[92:95], v17 offset:528
  ds_write_b16 v18, v24
  s_bitcmp1_b32 s42, 1
  s_waitcnt vmcnt(8)
  s_mov_b64 exec, 1
  ds_inc_u32 v15, v15 offset:512
  s_mov_b64 exec, -1
  ds_read_b128 v[48:51], v16 offset:1056
  ds_read_b128 v[52:55], v17 offset:1056
  ds_read_b128 v[56:59], v16 offset:1584
  ds_read_b128 v[60:63], v17 offset:1584
  s_cbranch_scc1 LB_fepi1
LB_fdone1:
  s_setprio 0
  v_exp_f32 v64, v64
  v_exp_f32 v65, v65
  s_waitcnt lgkmcnt(4)
  v_mfma_f32_32x32x16_bf16 v[96:111], v[80:83], v[192:195], v[128:143]
  v_exp_f32 v66, v66
  v_exp_f32 v67, v67
  v_exp_f32 v68, v68
  v_mfma_f32_32x32x16_bf16 v[96:111], v[84:87], v[196:199], v[96:111]
  v_exp_f32 v69, v69
  v_exp_f32 v70, v70
  v_exp_f32 v71, v71
  v_mfma_f32_32x32x16_bf16 v[112:127], v[88:91], v[200:203], v[144:159]
  v_exp_f32 v72, v72
  v_exp_f32 v73, v73
  v_exp_f32 v74, v74
  v_mfma_f32_32x32x16_bf16 v[112:127], v[92:95], v[204:207], v[112:127]
  v_exp_f32 v75, v75
  v_exp_f32 v76, v76
  v_exp_f32 v77, v77
  v_exp_f32 v78, v78
  v_exp_f32 v79, v79
  v_add_f32 v64, 1.0, v64
  v_add_f32 v65, 1.0, v65
  v_add_f32 v66, 1.0, v66
  s_setprio 2
  v_add_f32 v67, 1.0, v67
  v_add_f32 v68, 1.0, v68
  v_add_f32 v69, 1.0, v69
  v_add_f32 v70, 1.0, v70
  v_add_f32 v71, 1.0, v71
  v_add_f32 v72, 1.0, v72
  v_add_f32 v73, 1.0, v73
  v_add_f32 v74, 1.0, v74
  v_add_f32 v75, 1.0, v75
  v_add_f32 v76, 1.0, v76
  v_add_f32 v77, 1.0, v77
  v_add_f32 v78, 1.0, v78
  v_add_f32 v79, 1.0, v79
  v_cvt_pk_bf16_f32 v224, v96, v97
  v_cvt_pk_bf16_f32 v225, v98, v99
  v_cvt_pk_bf16_f32 v226, v100, v101
  v_cvt_pk_bf16_f32 v227, v102, v103
  v_cvt_pk_bf16_f32 v228, v104, v105
  v_cvt_pk_bf16_f32 v229, v106, v107
  v_cvt_pk_bf16_f32 v230, v108, v109
  v_cvt_pk_bf16_f32 v231, v110, v111
  v_cvt_pk_bf16_f32 v232, v112, v113
  v_cvt_pk_bf16_f32 v233, v114, v115
  v_cvt_pk_bf16_f32 v234, v116, v117
  v_cvt_pk_bf16_f32 v235, v118, v119
  v_cvt_pk_bf16_f32 v236, v120, v121
  v_cvt_pk_bf16_f32 v237, v122, v123
  v_cvt_pk_bf16_f32 v238, v124, v125
  v_cvt_pk_bf16_f32 v239, v126, v127
  v_rcp_f32 v64, v64
  v_rcp_f32 v65, v65
  v_rcp_f32 v66, v66
  v_rcp_f32 v67, v67
  v_rcp_f32 v68, v68
  v_rcp_f32 v69, v69
  v_rcp_f32 v70, v70
  v_rcp_f32 v71, v71
  v_cvt_pk_bf16_f32 v64, v64, v65
  v_cvt_pk_bf16_f32 v65, v66, v67
  v_cvt_pk_bf16_f32 v66, v68, v69
  v_cvt_pk_bf16_f32 v67, v70, v71
  s_waitcnt lgkmcnt(0)
  v_mfma_f32_32x32x16_bf16 v[96:111], v[48:51], v[208:211], v[160:175]
  v_rcp_f32 v72, v72
  v_rcp_f32 v73, v73
  v_rcp_f32 v74, v74
  v_mfma_f32_32x32x16_bf16 v[96:111], v[52:55], v[212:215], v[96:111]
  v_rcp_f32 v75, v75
  v_rcp_f32 v76, v76
  v_rcp_f32 v77, v77
  v_mfma_f32_32x32x16_bf16 v[112:127], v[56:59], v[216:219], v[176:191]
  v_rcp_f32 v78, v78
  v_rcp_f32 v79, v79
  v_mfma_f32_32x32x16_bf16 v[112:127], v[60:63], v[220:223], v[112:127]
  ds_read_b128 v[48:51], v19 offset:0
  ds_read_b128 v[52:55], v19 offset:32
  ds_read_b128 v[56:59], v19 offset:64
  ds_read_b128 v[60:63], v19 offset:96
  v_cvt_pk_bf16_f32 v68, v72, v73
  v_cvt_pk_bf16_f32 v69, v74, v75
  v_cvt_pk_bf16_f32 v70, v76, v77
  v_cvt_pk_bf16_f32 v71, v78, v79
  v_alignbit_b32 v24, v25, v24, 16
  v_alignbit_b32 v25, v26, v25, 16
  v_alignbit_b32 v26, v27, v26, 16
  v_lshrrev_b32 v27, 16, v27
  v_add_u32 v19, 0x200, v19
  v_add_u32 v16, s44, v16
  v_add_u32 v17, s44, v17
  s_sub_u32 s44, 0, s44
  v_add_u32 v18, s44, v18
  v_cvt_pk_bf16_f32 v240, v96, v97
  v_cvt_pk_bf16_f32 v241, v98, v99
  v_cvt_pk_bf16_f32 v242, v100, v101
  v_cvt_pk_bf16_f32 v243, v102, v103
  v_cvt_pk_bf16_f32 v244, v104, v105
  v_cvt_pk_bf16_f32 v245, v106, v107
  ds_read_b32 v21, v15 offset:512
  v_cvt_pk_bf16_f32 v246, v108, v109
  v_cvt_pk_bf16_f32 v247, v110, v111
  v_cvt_pk_bf16_f32 v248, v112, v113
  v_cvt_pk_bf16_f32 v249, v114, v115
  v_cvt_pk_bf16_f32 v250, v116, v117
  v_cvt_pk_bf16_f32 v251, v118, v119
  v_cvt_pk_bf16_f32 v252, v120, v121
  v_cvt_pk_bf16_f32 v253, v122, v123
  v_cvt_pk_bf16_f32 v254, v124, v125
  v_cvt_pk_bf16_f32 v255, v126, v127
  s_branch LB_vj1
LB_first2:
  ds_read_b128 v[80:83], v16 offset:0
  ds_read_b128 v[84:87], v17 offset:0
  ds_read_b128 v[88:91], v16 offset:528
  ds_read_b128 v[92:95], v17 offset:528
  ds_write_b16 v18, v24
  s_bitcmp1_b32 s42, 2
  s_waitcnt vmcnt(8)
  s_mov_b64 exec, 1
  ds_inc_u32 v15, v15 offset:512
  s_mov_b64 exec, -1
  ds_read_b128 v[48:51], v16 offset:1056
  ds_read_b128 v[52:55], v17 offset:1056
  ds_read_b128 v[56:59], v16 offset:1584
  ds_read_b128 v[60:63], v17 offset:1584
  s_cbranch_scc1 LB_fepi2
LB_fdone2:
  s_setprio 0
  v_exp_f32 v64, v64
  v_exp_f32 v65, v65
  s_waitcnt lgkmcnt(4)
  v_mfma_f32_32x32x16_bf16 v[96:111], v[80:83], v[192:195], v[128:143]
  v_exp_f32 v66, v66
  v_exp_f32 v67, v67
  v_exp_f32 v68, v68
  v_mfma_f32_32x32x16_bf16 v[96:111], v[84:87], v[196:199], v[96:111]
  v_exp_f32 v69, v69
  v_exp_f32 v70, v70
  v_exp_f32 v71, v71
  v_mfma_f32_32x32x16_bf16 v[112:127], v[88:91], v[200:203], v[144:159]
  v_exp_f32 v72, v72
  v_exp_f32 v73, v73
  v_exp_f32 v74, v74
  v_mfma_f32_32x32x16_bf16 v[112:127], v[92:95], v[204:207], v[112:127]
  v_exp_f32 v75, v75
  v_exp_f32 v76, v76
  v_exp_f32 v77, v77
  v_exp_f32 v78, v78
  v_exp_f32 v79, v79
  v_add_f32 v64, 1.0, v64
  v_add_f32 v65, 1.0, v65
  v_add_f32 v66, 1.0, v66
  s_setprio 2
  v_add_f32 v67, 1.0, v67
  v_add_f32 v68, 1.0, v68
  v_add_f32 v69, 1.0, v69
  v_add_f32 v70, 1.0, v70
  v_add_f32 v71, 1.0, v71
  v_add_f32 v72, 1.0, v72
  v_add_f32 v73, 1.0, v73
  v_add_f32 v74, 1.0, v74
  v_add_f32 v75, 1.0, v75
  v_add_f32 v76, 1.0, v76
  v_add_f32 v77, 1.0, v77
  v_add_f32 v78, 1.0, v78
  v_add_f32 v79, 1.0, v79
  v_cvt_pk_bf16_f32 v224, v96, v97
  v_cvt_pk_bf16_f32 v225, v98, v99
  v_cvt_pk_bf16_f32 v226, v100, v101
  v_cvt_pk_bf16_f32 v227, v102, v103
  v_cvt_pk_bf16_f32 v228, v104, v105
  v_cvt_pk_bf16_f32 v229, v106, v107
  v_cvt_pk_bf16_f32 v230, v108, v109
  v_cvt_pk_bf16_f32 v231, v110, v111
  v_cvt_pk_bf16_f32 v232, v112, v113
  v_cvt_pk_bf16_f32 v233, v114, v115
  v_cvt_pk_bf16_f32 v234, v116, v117
  v_cvt_pk_bf16_f32 v235, v118, v119
  v_cvt_pk_bf16_f32 v236, v120, v121
  v_cvt_pk_bf16_f32 v237, v122, v123
  v_cvt_pk_bf16_f32 v238, v124, v125
  v_cvt_pk_bf16_f32 v239, v126, v127
  v_rcp_f32 v64, v64
  v_rcp_f32 v65, v65
  v_rcp_f32 v66, v66
  v_rcp_f32 v67, v67
  v_rcp_f32 v68, v68
  v_rcp_f32 v69, v69
  v_rcp_f32 v70, v70
  v_rcp_f32 v71, v71
  v_cvt_pk_bf16_f32 v64, v64, v65
  v_cvt_pk_bf16_f32 v65, v66, v67
  v_cvt_pk_bf16_f32 v66, v68, v69
  v_cvt_pk_bf16_f32 v67, v70, v71
  s_waitcnt lgkmcnt(0)
  v_mfma_f32_32x32x16_bf16 v[96:111], v[48:51], v[208:211], v[160:175]
  v_rcp_f32 v72, v72
  v_rcp_f32 v73, v73
  v_rcp_f32 v74, v74
  v_mfma_f32_32x32x16_bf16 v[96:111], v[52:55], v[212:215], v[96:111]
  v_rcp_f32 v75, v75
  v_rcp_f32 v76, v76
  v_rcp_f32 v77, v77
  v_mfma_f32_32x32x16_bf16 v[112:127], v[56:59], v[216:219], v[176:191]
  v_rcp_f32 v78, v78
  v_rcp_f32 v79, v79
  v_mfma_f32_32x32x16_bf16 v[112:127], v[60:63], v[220:223], v[112:127]
  ds_read_b128 v[48:51], v19 offset:0
  ds_read_b128 v[52:55], v19 offset:32
  ds_read_b128 v[56:59], v19 offset:64
  ds_read_b128 v[60:63], v19 offset:96
  v_cvt_pk_bf16_f32 v68, v72, v73
  v_cvt_pk_bf16_f32 v69, v74, v75
  v_cvt_pk_bf16_f32 v70, v76, v77
  v_cvt_pk_bf16_f32 v71, v78, v79
  v_alignbit_b32 v24, v25, v24, 16
  v_alignbit_b32 v25, v26, v25, 16
  v_alignbit_b32 v26, v27, v26, 16
  v_lshrrev_b32 v27, 16, v27
  v_add_u32 v19, 0x200, v19
  v_add_u32 v16, s44, v16
  v_add_u32 v17, s44, v17
  s_sub_u32 s44, 0, s44
  v_add_u32 v18, s44, v18
  v_cvt_pk_bf16_f32 v240, v96, v97
  v_cvt_pk_bf16_f32 v241, v98, v99
  v_cvt_pk_bf16_f32 v242, v100, v101
  v_cvt_pk_bf16_f32 v243, v102, v103
  v_cvt_pk_bf16_f32 v244, v104, v105
  v_cvt_pk_bf16_f32 v245, v106, v107
  ds_read_b32 v21, v15 offset:512
  v_cvt_pk_bf16_f32 v246, v108, v109
  v_cvt_pk_bf16_f32 v247, v110, v111
  v_cvt_pk_bf16_f32 v248, v112, v113
  v_cvt_pk_bf16_f32 v249, v114, v115
  v_cvt_pk_bf16_f32 v250, v116, v117
  v_cvt_pk_bf16_f32 v251, v118, v119
  v_cvt_pk_bf16_f32 v252, v120, v121
  v_cvt_pk_bf16_f32 v253, v122, v123
  v_cvt_pk_bf16_f32 v254, v124, v125
  v_cvt_pk_bf16_f32 v255, v126, v127
  s_branch LB_vj2
LB_first3:
  ds_read_b128 v[80:83], v16 offset:0
  ds_read_b128 v[84:87], v17 offset:0
  ds_read_b128 v[88:91], v16 offset:528
  ds_read_b128 v[92:95], v17 offset:528
  ds_write_b16 v18, v24
  s_bitcmp1_b32 s42, 3
  s_waitcnt vmcnt(8)
  s_mov_b64 exec, 1
  ds_inc_u32 v15, v15 offset:512
  s_mov_b64 exec, -1
  ds_read_b128 v[48:51], v16 offset:1056
  ds_read_b128 v[52:55], v17 offset:1056
  ds_read_b128 v[56:59], v16 offset:1584
  ds_read_b128 v[60:63], v17 offset:1584
  s_cbranch_scc1 LB_fepi3
LB_fdone3:
  s_setprio 0
  v_exp_f32 v64, v64
  v_exp_f32 v65, v65
  s_waitcnt lgkmcnt(4)
  v_mfma_f32_32x32x16_bf16 v[96:111], v[80:83], v[192:195], v[128:143]
  v_exp_f32 v66, v66
  v_exp_f32 v67, v67
  v_exp_f32 v68, v68
  v_mfma_f32_32x32x16_bf16 v[96:111], v[84:87], v[196:199], v[96:111]
  v_exp_f32 v69, v69
  v_exp_f32 v70, v70
  v_exp_f32 v71, v71
  v_mfma_f32_32x32x16_bf16 v[112:127], v[88:91], v[200:203], v[144:159]
  v_exp_f32 v72, v72
  v_exp_f32 v73, v73
  v_exp_f32 v74, v74
  v_mfma_f32_32x32x16_bf16 v[112:127], v[92:95], v[204:207], v[112:127]
  v_exp_f32 v75, v75
  v_exp_f32 v76, v76
  v_exp_f32 v77, v77
  v_exp_f32 v78, v78
  v_exp_f32 v79, v79
  v_add_f32 v64, 1.0, v64
  v_add_f32 v65, 1.0, v65
  v_add_f32 v66, 1.0, v66
  s_setprio 2
  v_add_f32 v67, 1.0, v67
  v_add_f32 v68, 1.0, v68
  v_add_f32 v69, 1.0, v69
  v_add_f32 v70, 1.0, v70
  v_add_f32 v71, 1.0, v71
  v_add_f32 v72, 1.0, v72
  v_add_f32 v73, 1.0, v73
  v_add_f32 v74, 1.0, v74
  v_add_f32 v75, 1.0, v75
  v_add_f32 v76, 1.0, v76
  v_add_f32 v77, 1.0, v77
  v_add_f32 v78, 1.0, v78
  v_add_f32 v79, 1.0, v79
  v_cvt_pk_bf16_f32 v224, v96, v97
  v_cvt_pk_bf16_f32 v225, v98, v99
  v_cvt_pk_bf16_f32 v226, v100, v101
  v_cvt_pk_bf16_f32 v227, v102, v103
  v_cvt_pk_bf16_f32 v228, v104, v105
  v_cvt_pk_bf16_f32 v229, v106, v107
  v_cvt_pk_bf16_f32 v230, v108, v109
  v_cvt_pk_bf16_f32 v231, v110, v111
  v_cvt_pk_bf16_f32 v232, v112, v113
  v_cvt_pk_bf16_f32 v233, v114, v115
  v_cvt_pk_bf16_f32 v234, v116, v117
  v_cvt_pk_bf16_f32 v235, v118, v119
  v_cvt_pk_bf16_f32 v236, v120, v121
  v_cvt_pk_bf16_f32 v237, v122, v123
  v_cvt_pk_bf16_f32 v238, v124, v125
  v_cvt_pk_bf16_f32 v239, v126, v127
  v_rcp_f32 v64, v64
  v_rcp_f32 v65, v65
  v_rcp_f32 v66, v66
  v_rcp_f32 v67, v67
  v_rcp_f32 v68, v68
  v_rcp_f32 v69, v69
  v_rcp_f32 v70, v70
  v_rcp_f32 v71, v71
  v_cvt_pk_bf16_f32 v64, v64, v65
  v_cvt_pk_bf16_f32 v65, v66, v67
  v_cvt_pk_bf16_f32 v66, v68, v69
  v_cvt_pk_bf16_f32 v67, v70, v71
  s_waitcnt lgkmcnt(0)
  v_mfma_f32_32x32x16_bf16 v[96:111], v[48:51], v[208:211], v[160:175]
  v_rcp_f32 v72, v72
  v_rcp_f32 v73, v73
  v_rcp_f32 v74, v74
  v_mfma_f32_32x32x16_bf16 v[96:111], v[52:55], v[212:215], v[96:111]
  v_rcp_f32 v75, v75
  v_rcp_f32 v76, v76
  v_rcp_f32 v77, v77
  v_mfma_f32_32x32x16_bf16 v[112:127], v[56:59], v[216:219], v[176:191]
  v_rcp_f32 v78, v78
  v_rcp_f32 v79, v79
  v_mfma_f32_32x32x16_bf16 v[112:127], v[60:63], v[220:223], v[112:127]
  ds_read_b128 v[48:51], v19 offset:0
  ds_read_b128 v[52:55], v19 offset:32
  ds_read_b128 v[56:59], v19 offset:64
  ds_read_b128 v[60:63], v19 offset:96
  v_cvt_pk_bf16_f32 v68, v72, v73
  v_cvt_pk_bf16_f32 v69, v74, v75
  v_cvt_pk_bf16_f32 v70, v76, v77
  v_cvt_pk_bf16_f32 v71, v78, v79
  v_alignbit_b32 v24, v25, v24, 16
  v_alignbit_b32 v25, v26, v25, 16
  v_alignbit_b32 v26, v27, v26, 16
  v_lshrrev_b32 v27, 16, v27
  v_add_u32 v19, 0x200, v19
  v_add_u32 v16, s44, v16
  v_add_u32 v17, s44, v17
  s_sub_u32 s44, 0, s44
  v_add_u32 v18, s44, v18
  v_cvt_pk_bf16_f32 v240, v96, v97
  v_cvt_pk_bf16_f32 v241, v98, v99
  v_cvt_pk_bf16_f32 v242, v100, v101
  v_cvt_pk_bf16_f32 v243, v102, v103
  v_cvt_pk_bf16_f32 v244, v104, v105
  v_cvt_pk_bf16_f32 v245, v106, v107
  ds_read_b32 v21, v15 offset:512
  v_cvt_pk_bf16_f32 v246, v108, v109
  v_cvt_pk_bf16_f32 v247, v110, v111
  v_cvt_pk_bf16_f32 v248, v112, v113
  v_cvt_pk_bf16_f32 v249, v114, v115
  v_cvt_pk_bf16_f32 v250, v116, v117
  v_cvt_pk_bf16_f32 v251, v118, v119
  v_cvt_pk_bf16_f32 v252, v120, v121
  v_cvt_pk_bf16_f32 v253, v122, v123
  v_cvt_pk_bf16_f32 v254, v124, v125
  v_cvt_pk_bf16_f32 v255, v126, v127
  s_branch LB_vj3
LB_first4:
  ds_read_b128 v[80:83], v16 offset:0
  ds_read_b128 v[84:87], v17 offset:0
  ds_read_b128 v[88:91], v16 offset:528
  ds_read_b128 v[92:95], v17 offset:528
  ds_write_b16 v18, v24
  s_bitcmp1_b32 s42, 4
  s_waitcnt vmcnt(8)
  s_mov_b64 exec, 1
  ds_inc_u32 v15, v15 offset:512
  s_mov_b64 exec, -1
  ds_read_b128 v[48:51], v16 offset:1056
  ds_read_b128 v[52:55], v17 offset:1056
  ds_read_b128 v[56:59], v16 offset:1584
  ds_read_b128 v[60:63], v17 offset:1584
  s_cbranch_scc1 LB_fepi4
LB_fdone4:
  s_setprio 0
  v_exp_f32 v64, v64
  v_exp_f32 v65, v65
  s_waitcnt lgkmcnt(4)
  v_mfma_f32_32x32x16_bf16 v[96:111], v[80:83], v[192:195], v[128:143]
  v_exp_f32 v66, v66
  v_exp_f32 v67, v67
  v_exp_f32 v68, v68
  v_mfma_f32_32x32x16_bf16 v[96:111], v[84:87], v[196:199], v[96:111]
  v_exp_f32 v69, v69
  v_exp_f32 v70, v70
  v_exp_f32 v71, v71
  v_mfma_f32_32x32x16_bf16 v[112:127], v[88:91], v[200:203], v[144:159]
  v_exp_f32 v72, v72
  v_exp_f32 v73, v73
  v_exp_f32 v74, v74
  v_mfma_f32_32x32x16_bf16 v[112:127], v[92:95], v[204:207], v[112:127]
  v_exp_f32 v75, v75
  v_exp_f32 v76, v76
  v_exp_f32 v77, v77
  v_exp_f32 v78, v78
  v_exp_f32 v79, v79
  v_add_f32 v64, 1.0, v64
  v_add_f32 v65, 1.0, v65
  v_add_f32 v66, 1.0, v66
  s_setprio 2
  v_add_f32 v67, 1.0, v67
  v_add_f32 v68, 1.0, v68
  v_add_f32 v69, 1.0, v69
  v_add_f32 v70, 1.0, v70
  v_add_f32 v71, 1.0, v71
  v_add_f32 v72, 1.0, v72
  v_add_f32 v73, 1.0, v73
  v_add_f32 v74, 1.0, v74
  v_add_f32 v75, 1.0, v75
  v_add_f32 v76, 1.0, v76
  v_add_f32 v77, 1.0, v77
  v_add_f32 v78, 1.0, v78
  v_add_f32 v79, 1.0, v79
  v_cvt_pk_bf16_f32 v224, v96, v97
  v_cvt_pk_bf16_f32 v225, v98, v99
  v_cvt_pk_bf16_f32 v226, v100, v101
  v_cvt_pk_bf16_f32 v227, v102, v103
  v_cvt_pk_bf16_f32 v228, v104, v105
  v_cvt_pk_bf16_f32 v229, v106, v107
  v_cvt_pk_bf16_f32 v230, v108, v109
  v_cvt_pk_bf16_f32 v231, v110, v111
  v_cvt_pk_bf16_f32 v232, v112, v113
  v_cvt_pk_bf16_f32 v233, v114, v115
  v_cvt_pk_bf16_f32 v234, v116, v117
  v_cvt_pk_bf16_f32 v235, v118, v119
  v_cvt_pk_bf16_f32 v236, v120, v121
  v_cvt_pk_bf16_f32 v237, v122, v123
  v_cvt_pk_bf16_f32 v238, v124, v125
  v_cvt_pk_bf16_f32 v239, v126, v127
  v_rcp_f32 v64, v64
  v_rcp_f32 v65, v65
  v_rcp_f32 v66, v66
  v_rcp_f32 v67, v67
  v_rcp_f32 v68, v68
  v_rcp_f32 v69, v69
  v_rcp_f32 v70, v70
  v_rcp_f32 v71, v71
  v_cvt_pk_bf16_f32 v64, v64, v65
  v_cvt_pk_bf16_f32 v65, v66, v67
  v_cvt_pk_bf16_f32 v66, v68, v69
  v_cvt_pk_bf16_f32 v67, v70, v71
  s_waitcnt lgkmcnt(0)
  v_mfma_f32_32x32x16_bf16 v[96:111], v[48:51], v[208:211], v[160:175]
  v_rcp_f32 v72, v72
  v_rcp_f32 v73, v73
  v_rcp_f32 v74, v74
  v_mfma_f32_32x32x16_bf16 v[96:111], v[52:55], v[212:215], v[96:111]
  v_rcp_f32 v75, v75
  v_rcp_f32 v76, v76
  v_rcp_f32 v77, v77
  v_mfma_f32_32x32x16_bf16 v[112:127], v[56:59], v[216:219], v[176:191]
  v_rcp_f32 v78, v78
  v_rcp_f32 v79, v79
  v_mfma_f32_32x32x16_bf16 v[112:127], v[60:63], v[220:223], v[112:127]
  ds_read_b128 v[48:51], v19 offset:0
  ds_read_b128 v[52:55], v19 offset:32
  ds_read_b128 v[56:59], v19 offset:64
  ds_read_b128 v[60:63], v19 offset:96
  v_cvt_pk_bf16_f32 v68, v72, v73
  v_cvt_pk_bf16_f32 v69, v74, v75
  v_cvt_pk_bf16_f32 v70, v76, v77
  v_cvt_pk_bf16_f32 v71, v78, v79
  v_alignbit_b32 v24, v25, v24, 16
  v_alignbit_b32 v25, v26, v25, 16
  v_alignbit_b32 v26, v27, v26, 16
  v_lshrrev_b32 v27, 16, v27
  v_add_u32 v19, 0x200, v19
  v_add_u32 v16, s44, v16
  v_add_u32 v17, s44, v17
  s_sub_u32 s44, 0, s44
  v_add_u32 v18, s44, v18
  v_cvt_pk_bf16_f32 v240, v96, v97
  v_cvt_pk_bf16_f32 v241, v98, v99
  v_cvt_pk_bf16_f32 v242, v100, v101
  v_cvt_pk_bf16_f32 v243, v102, v103
  v_cvt_pk_bf16_f32 v244, v104, v105
  v_cvt_pk_bf16_f32 v245, v106, v107
  ds_read_b32 v21, v15 offset:512
  v_cvt_pk_bf16_f32 v246, v108, v109
  v_cvt_pk_bf16_f32 v247, v110, v111
  v_cvt_pk_bf16_f32 v248, v112, v113
  v_cvt_pk_bf16_f32 v249, v114, v115
  v_cvt_pk_bf16_f32 v250, v116, v117
  v_cvt_pk_bf16_f32 v251, v118, v119
  v_cvt_pk_bf16_f32 v252, v120, v121
  v_cvt_pk_bf16_f32 v253, v122, v123
  v_cvt_pk_bf16_f32 v254, v124, v125
  v_cvt_pk_bf16_f32 v255, v126, v127
  s_branch LB_vj4
LB_first5:
  ds_read_b128 v[80:83], v16 offset:0
  ds_read_b128 v[84:87], v17 offset:0
  ds_read_b128 v[88:91], v16 offset:528
  ds_read_b128 v[92:95], v17 offset:528
  ds_write_b16 v18, v24
  s_bitcmp1_b32 s42, 5
  s_waitcnt vmcnt(8)
  s_mov_b64 exec, 1
  ds_inc_u32 v15, v15 offset:512
  s_mov_b64 exec, -1
  ds_read_b128 v[48:51], v16 offset:1056
  ds_read_b128 v[52:55], v17 offset:1056
  ds_read_b128 v[56:59], v16 offset:1584
  ds_read_b128 v[60:63], v17 offset:1584
  s_cbranch_scc1 LB_fepi5
LB_fdone5:
  s_setprio 0
  v_exp_f32 v64, v64
  v_exp_f32 v65, v65
  s_waitcnt lgkmcnt(4)
  v_mfma_f32_32x32x16_bf16 v[96:111], v[80:83], v[192:195], v[128:143]
  v_exp_f32 v66, v66
  v_exp_f32 v67, v67
  v_exp_f32 v68, v68
  v_mfma_f32_32x32x16_bf16 v[96:111], v[84:87], v[196:199], v[96:111]
  v_exp_f32 v69, v69
  v_exp_f32 v70, v70
  v_exp_f32 v71, v71
  v_mfma_f32_32x32x16_bf16 v[112:127], v[88:91], v[200:203], v[144:159]
  v_exp_f32 v72, v72
  v_exp_f32 v73, v73
  v_exp_f32 v74, v74
  v_mfma_f32_32x32x16_bf16 v[112:127], v[92:95], v[204:207], v[112:127]
  v_exp_f32 v75, v75
  v_exp_f32 v76, v76
  v_exp_f32 v77, v77
  v_exp_f32 v78, v78
  v_exp_f32 v79, v79
  v_add_f32 v64, 1.0, v64
  v_add_f32 v65, 1.0, v65
  v_add_f32 v66, 1.0, v66
  s_setprio 2
  v_add_f32 v67, 1.0, v67
  v_add_f32 v68, 1.0, v68
  v_add_f32 v69, 1.0, v69
  v_add_f32 v70, 1.0, v70
  v_add_f32 v71, 1.0, v71
  v_add_f32 v72, 1.0, v72
  v_add_f32 v73, 1.0, v73
  v_add_f32 v74, 1.0, v74
  v_add_f32 v75, 1.0, v75
  v_add_f32 v76, 1.0, v76
  v_add_f32 v77, 1.0, v77
  v_add_f32 v78, 1.0, v78
  v_add_f32 v79, 1.0, v79
  v_cvt_pk_bf16_f32 v224, v96, v97
  v_cvt_pk_bf16_f32 v225, v98, v99
  v_cvt_pk_bf16_f32 v226, v100, v101
  v_cvt_pk_bf16_f32 v227, v102, v103
  v_cvt_pk_bf16_f32 v228, v104, v105
  v_cvt_pk_bf16_f32 v229, v106, v107
  v_cvt_pk_bf16_f32 v230, v108, v109
  v_cvt_pk_bf16_f32 v231, v110, v111
  v_cvt_pk_bf16_f32 v232, v112, v113
  v_cvt_pk_bf16_f32 v233, v114, v115
  v_cvt_pk_bf16_f32 v234, v116, v117
  v_cvt_pk_bf16_f32 v235, v118, v119
  v_cvt_pk_bf16_f32 v236, v120, v121
  v_cvt_pk_bf16_f32 v237, v122, v123
  v_cvt_pk_bf16_f32 v238, v124, v125
  v_cvt_pk_bf16_f32 v239, v126, v127
  v_rcp_f32 v64, v64
  v_rcp_f32 v65, v65
  v_rcp_f32 v66, v66
  v_rcp_f32 v67, v67
  v_rcp_f32 v68, v68
  v_rcp_f32 v69, v69
  v_rcp_f32 v70, v70
  v_rcp_f32 v71, v71
  v_cvt_pk_bf16_f32 v64, v64, v65
  v_cvt_pk_bf16_f32 v65, v66, v67
  v_cvt_pk_bf16_f32 v66, v68, v69
  v_cvt_pk_bf16_f32 v67, v70, v71
  s_waitcnt lgkmcnt(0)
  v_mfma_f32_32x32x16_bf16 v[96:111], v[48:51], v[208:211], v[160:175]
  v_rcp_f32 v72, v72
  v_rcp_f32 v73, v73
  v_rcp_f32 v74, v74
  v_mfma_f32_32x32x16_bf16 v[96:111], v[52:55], v[212:215], v[96:111]
  v_rcp_f32 v75, v75
  v_rcp_f32 v76, v76
  v_rcp_f32 v77, v77
  v_mfma_f32_32x32x16_bf16 v[112:127], v[56:59], v[216:219], v[176:191]
  v_rcp_f32 v78, v78
  v_rcp_f32 v79, v79
  v_mfma_f32_32x32x16_bf16 v[112:127], v[60:63], v[220:223], v[112:127]
  ds_read_b128 v[48:51], v19 offset:0
  ds_read_b128 v[52:55], v19 offset:32
  ds_read_b128 v[56:59], v19 offset:64
  ds_read_b128 v[60:63], v19 offset:96
  v_cvt_pk_bf16_f32 v68, v72, v73
  v_cvt_pk_bf16_f32 v69, v74, v75
  v_cvt_pk_bf16_f32 v70, v76, v77
  v_cvt_pk_bf16_f32 v71, v78, v79
  v_alignbit_b32 v24, v25, v24, 16
  v_alignbit_b32 v25, v26, v25, 16
  v_alignbit_b32 v26, v27, v26, 16
  v_lshrrev_b32 v27, 16, v27
  v_add_u32 v19, 0x200, v19
  v_add_u32 v16, s44, v16
  v_add_u32 v17, s44, v17
  s_sub_u32 s44, 0, s44
  v_add_u32 v18, s44, v18
  v_cvt_pk_bf16_f32 v240, v96, v97
  v_cvt_pk_bf16_f32 v241, v98, v99
  v_cvt_pk_bf16_f32 v242, v100, v101
  v_cvt_pk_bf16_f32 v243, v102, v103
  v_cvt_pk_bf16_f32 v244, v104, v105
  v_cvt_pk_bf16_f32 v245, v106, v107
  ds_read_b32 v21, v15 offset:512
  v_cvt_pk_bf16_f32 v246, v108, v109
  v_cvt_pk_bf16_f32 v247, v110, v111
  v_cvt_pk_bf16_f32 v248, v112, v113
  v_cvt_pk_bf16_f32 v249, v114, v115
  v_cvt_pk_bf16_f32 v250, v116, v117
  v_cvt_pk_bf16_f32 v251, v118, v119
  v_cvt_pk_bf16_f32 v252, v120, v121
  v_cvt_pk_bf16_f32 v253, v122, v123
  v_cvt_pk_bf16_f32 v254, v124, v125
  v_cvt_pk_bf16_f32 v255, v126, v127
  s_branch LB_vj5
LB_first6:
  ds_read_b128 v[80:83], v16 offset:0
  ds_read_b128 v[84:87], v17 offset:0
  ds_read_b128 v[88:91], v16 offset:528
  ds_read_b128 v[92:95], v17 offset:528
  ds_write_b16 v18, v24
  s_bitcmp1_b32 s42, 6
  s_waitcnt vmcnt(8)
  s_mov_b64 exec, 1
  ds_inc_u32 v15, v15 offset:512
  s_mov_b64 exec, -1
  ds_read_b128 v[48:51], v16 offset:1056
  ds_read_b128 v[52:55], v17 offset:1056
  ds_read_b128 v[56:59], v16 offset:1584
  ds_read_b128 v[60:63], v17 offset:1584
  s_cbranch_scc1 LB_fepi6
LB_fdone6:
  s_setprio 0
  v_exp_f32 v64, v64
  v_exp_f32 v65, v65
  s_waitcnt lgkmcnt(4)
  v_mfma_f32_32x32x16_bf16 v[96:111], v[80:83], v[192:195], v[128:143]
  v_exp_f32 v66, v66
  v_exp_f32 v67, v67
  v_exp_f32 v68, v68
  v_mfma_f32_32x32x16_bf16 v[96:111], v[84:87], v[196:199], v[96:111]
  v_exp_f32 v69, v69
  v_exp_f32 v70, v70
  v_exp_f32 v71, v71
  v_mfma_f32_32x32x16_bf16 v[112:127], v[88:91], v[200:203], v[144:159]
  v_exp_f32 v72, v72
  v_exp_f32 v73, v73
  v_exp_f32 v74, v74
  v_mfma_f32_32x32x16_bf16 v[112:127], v[92:95], v[204:207], v[112:127]
  v_exp_f32 v75, v75
  v_exp_f32 v76, v76
  v_exp_f32 v77, v77
  v_exp_f32 v78, v78
  v_exp_f32 v79, v79
  v_add_f32 v64, 1.0, v64
  v_add_f32 v65, 1.0, v65
  v_add_f32 v66, 1.0, v66
  s_setprio 2
  v_add_f32 v67, 1.0, v67
  v_add_f32 v68, 1.0, v68
  v_add_f32 v69, 1.0, v69
  v_add_f32 v70, 1.0, v70
  v_add_f32 v71, 1.0, v71
  v_add_f32 v72, 1.0, v72
  v_add_f32 v73, 1.0, v73
  v_add_f32 v74, 1.0, v74
  v_add_f32 v75, 1.0, v75
  v_add_f32 v76, 1.0, v76
  v_add_f32 v77, 1.0, v77
  v_add_f32 v78, 1.0, v78
  v_add_f32 v79, 1.0, v79
  v_cvt_pk_bf16_f32 v224, v96, v97
  v_cvt_pk_bf16_f32 v225, v98, v99
  v_cvt_pk_bf16_f32 v226, v100, v101
  v_cvt_pk_bf16_f32 v227, v102, v103
  v_cvt_pk_bf16_f32 v228, v104, v105
  v_cvt_pk_bf16_f32 v229, v106, v107
  v_cvt_pk_bf16_f32 v230, v108, v109
  v_cvt_pk_bf16_f32 v231, v110, v111
  v_cvt_pk_bf16_f32 v232, v112, v113
  v_cvt_pk_bf16_f32 v233, v114, v115
  v_cvt_pk_bf16_f32 v234, v116, v117
  v_cvt_pk_bf16_f32 v235, v118, v119
  v_cvt_pk_bf16_f32 v236, v120, v121
  v_cvt_pk_bf16_f32 v237, v122, v123
  v_cvt_pk_bf16_f32 v238, v124, v125
  v_cvt_pk_bf16_f32 v239, v126, v127
  v_rcp_f32 v64, v64
  v_rcp_f32 v65, v65
  v_rcp_f32 v66, v66
  v_rcp_f32 v67, v67
  v_rcp_f32 v68, v68
  v_rcp_f32 v69, v69
  v_rcp_f32 v70, v70
  v_rcp_f32 v71, v71
  v_cvt_pk_bf16_f32 v64, v64, v65
  v_cvt_pk_bf16_f32 v65, v66, v67
  v_cvt_pk_bf16_f32 v66, v68, v69
  v_cvt_pk_bf16_f32 v67, v70, v71
  s_waitcnt lgkmcnt(0)
  v_mfma_f32_32x32x16_bf16 v[96:111], v[48:51], v[208:211], v[160:175]
  v_rcp_f32 v72, v72
  v_rcp_f32 v73, v73
  v_rcp_f32 v74, v74
  v_mfma_f32_32x32x16_bf16 v[96:111], v[52:55], v[212:215], v[96:111]
  v_rcp_f32 v75, v75
  v_rcp_f32 v76, v76
  v_rcp_f32 v77, v77
  v_mfma_f32_32x32x16_bf16 v[112:127], v[56:59], v[216:219], v[176:191]
  v_rcp_f32 v78, v78
  v_rcp_f32 v79, v79
  v_mfma_f32_32x32x16_bf16 v[112:127], v[60:63], v[220:223], v[112:127]
  ds_read_b128 v[48:51], v19 offset:0
  ds_read_b128 v[52:55], v19 offset:32
  ds_read_b128 v[56:59], v19 offset:64
  ds_read_b128 v[60:63], v19 offset:96
  v_cvt_pk_bf16_f32 v68, v72, v73
  v_cvt_pk_bf16_f32 v69, v74, v75
  v_cvt_pk_bf16_f32 v70, v76, v77
  v_cvt_pk_bf16_f32 v71, v78, v79
  v_alignbit_b32 v24, v25, v24, 16
  v_alignbit_b32 v25, v26, v25, 16
  v_alignbit_b32 v26, v27, v26, 16
  v_lshrrev_b32 v27, 16, v27
  v_add_u32 v19, 0x200, v19
  v_add_u32 v16, s44, v16
  v_add_u32 v17, s44, v17
  s_sub_u32 s44, 0, s44
  v_add_u32 v18, s44, v18
  v_cvt_pk_bf16_f32 v240, v96, v97
  v_cvt_pk_bf16_f32 v241, v98, v99
  v_cvt_pk_bf16_f32 v242, v100, v101
  v_cvt_pk_bf16_f32 v243, v102, v103
  v_cvt_pk_bf16_f32 v244, v104, v105
  v_cvt_pk_bf16_f32 v245, v106, v107
  ds_read_b32 v21, v15 offset:512
  v_cvt_pk_bf16_f32 v246, v108, v109
  v_cvt_pk_bf16_f32 v247, v110, v111
  v_cvt_pk_bf16_f32 v248, v112, v113
  v_cvt_pk_bf16_f32 v249, v114, v115
  v_cvt_pk_bf16_f32 v250, v116, v117
  v_cvt_pk_bf16_f32 v251, v118, v119
  v_cvt_pk_bf16_f32 v252, v120, v121
  v_cvt_pk_bf16_f32 v253, v122, v123
  v_cvt_pk_bf16_f32 v254, v124, v125
  v_cvt_pk_bf16_f32 v255, v126, v127
  s_branch LB_vj6
LB_first7:
  ds_read_b128 v[80:83], v16 offset:0
  ds_read_b128 v[84:87], v17 offset:0
  ds_read_b128 v[88:91], v16 offset:528
  ds_read_b128 v[92:95], v17 offset:528
  ds_write_b16 v18, v24
  s_bitcmp1_b32 s42, 7
  s_waitcnt vmcnt(8)
  s_mov_b64 exec, 1
  ds_inc_u32 v15, v15 offset:512
  s_mov_b64 exec, -1
  ds_read_b128 v[48:51], v16 offset:1056
  ds_read_b128 v[52:55], v17 offset:1056
  ds_read_b128 v[56:59], v16 offset:1584
  ds_read_b128 v[60:63], v17 offset:1584
  s_cbranch_scc1 LB_fepi7
LB_fdone7:
  s_setprio 0
  v_exp_f32 v64, v64
  v_exp_f32 v65, v65
  s_waitcnt lgkmcnt(4)
  v_mfma_f32_32x32x16_bf16 v[96:111], v[80:83], v[192:195], v[128:143]
  v_exp_f32 v66, v66
  v_exp_f32 v67, v67
  v_exp_f32 v68, v68
  v_mfma_f32_32x32x16_bf16 v[96:111], v[84:87], v[196:199], v[96:111]
  v_exp_f32 v69, v69
  v_exp_f32 v70, v70
  v_exp_f32 v71, v71
  v_mfma_f32_32x32x16_bf16 v[112:127], v[88:91], v[200:203], v[144:159]
  v_exp_f32 v72, v72
  v_exp_f32 v73, v73
  v_exp_f32 v74, v74
  v_mfma_f32_32x32x16_bf16 v[112:127], v[92:95], v[204:207], v[112:127]
  v_exp_f32 v75, v75
  v_exp_f32 v76, v76
  v_exp_f32 v77, v77
  v_exp_f32 v78, v78
  v_exp_f32 v79, v79
  v_add_f32 v64, 1.0, v64
  v_add_f32 v65, 1.0, v65
  v_add_f32 v66, 1.0, v66
  s_setprio 2
  v_add_f32 v67, 1.0, v67
  v_add_f32 v68, 1.0, v68
  v_add_f32 v69, 1.0, v69
  v_add_f32 v70, 1.0, v70
  v_add_f32 v71, 1.0, v71
  v_add_f32 v72, 1.0, v72
  v_add_f32 v73, 1.0, v73
  v_add_f32 v74, 1.0, v74
  v_add_f32 v75, 1.0, v75
  v_add_f32 v76, 1.0, v76
  v_add_f32 v77, 1.0, v77
  v_add_f32 v78, 1.0, v78
  v_add_f32 v79, 1.0, v79
  v_cvt_pk_bf16_f32 v224, v96, v97
  v_cvt_pk_bf16_f32 v225, v98, v99
  v_cvt_pk_bf16_f32 v226, v100, v101
  v_cvt_pk_bf16_f32 v227, v102, v103
  v_cvt_pk_bf16_f32 v228, v104, v105
  v_cvt_pk_bf16_f32 v229, v106, v107
  v_cvt_pk_bf16_f32 v230, v108, v109
  v_cvt_pk_bf16_f32 v231, v110, v111
  v_cvt_pk_bf16_f32 v232, v112, v113
  v_cvt_pk_bf16_f32 v233, v114, v115
  v_cvt_pk_bf16_f32 v234, v116, v117
  v_cvt_pk_bf16_f32 v235, v118, v119
  v_cvt_pk_bf16_f32 v236, v120, v121
  v_cvt_pk_bf16_f32 v237, v122, v123
  v_cvt_pk_bf16_f32 v238, v124, v125
  v_cvt_pk_bf16_f32 v239, v126, v127
  v_rcp_f32 v64, v64
  v_rcp_f32 v65, v65
  v_rcp_f32 v66, v66
  v_rcp_f32 v67, v67
  v_rcp_f32 v68, v68
  v_rcp_f32 v69, v69
  v_rcp_f32 v70, v70
  v_rcp_f32 v71, v71
  v_cvt_pk_bf16_f32 v64, v64, v65
  v_cvt_pk_bf16_f32 v65, v66, v67
  v_cvt_pk_bf16_f32 v66, v68, v69
  v_cvt_pk_bf16_f32 v67, v70, v71
  s_waitcnt lgkmcnt(0)
  v_mfma_f32_32x32x16_bf16 v[96:111], v[48:51], v[208:211], v[160:175]
  v_rcp_f32 v72, v72
  v_rcp_f32 v73, v73
  v_rcp_f32 v74, v74
  v_mfma_f32_32x32x16_bf16 v[96:111], v[52:55], v[212:215], v[96:111]
  v_rcp_f32 v75, v75
  v_rcp_f32 v76, v76
  v_rcp_f32 v77, v77
  v_mfma_f32_32x32x16_bf16 v[112:127], v[56:59], v[216:219], v[176:191]
  v_rcp_f32 v78, v78
  v_rcp_f32 v79, v79
  v_mfma_f32_32x32x16_bf16 v[112:127], v[60:63], v[220:223], v[112:127]
  ds_read_b128 v[48:51], v19 offset:0
  ds_read_b128 v[52:55], v19 offset:32
  ds_read_b128 v[56:59], v19 offset:64
  ds_read_b128 v[60:63], v19 offset:96
  v_cvt_pk_bf16_f32 v68, v72, v73
  v_cvt_pk_bf16_f32 v69, v74, v75
  v_cvt_pk_bf16_f32 v70, v76, v77
  v_cvt_pk_bf16_f32 v71, v78, v79
  v_alignbit_b32 v24, v25, v24, 16
  v_alignbit_b32 v25, v26, v25, 16
  v_alignbit_b32 v26, v27, v26, 16
  v_lshrrev_b32 v27, 16, v27
  v_add_u32 v19, 0x200, v19
  v_add_u32 v16, s44, v16
  v_add_u32 v17, s44, v17
  s_sub_u32 s44, 0, s44
  v_add_u32 v18, s44, v18
  v_cvt_pk_bf16_f32 v240, v96, v97
  v_cvt_pk_bf16_f32 v241, v98, v99
  v_cvt_pk_bf16_f32 v242, v100, v101
  v_cvt_pk_bf16_f32 v243, v102, v103
  v_cvt_pk_bf16_f32 v244, v104, v105
  v_cvt_pk_bf16_f32 v245, v106, v107
  ds_read_b32 v21, v15 offset:512
  v_cvt_pk_bf16_f32 v246, v108, v109
  v_cvt_pk_bf16_f32 v247, v110, v111
  v_cvt_pk_bf16_f32 v248, v112, v113
  v_cvt_pk_bf16_f32 v249, v114, v115
  v_cvt_pk_bf16_f32 v250, v116, v117
  v_cvt_pk_bf16_f32 v251, v118, v119
  v_cvt_pk_bf16_f32 v252, v120, v121
  v_cvt_pk_bf16_f32 v253, v122, v123
  v_cvt_pk_bf16_f32 v254, v124, v125
  v_cvt_pk_bf16_f32 v255, v126, v127
  s_branch LB_vj7
LB_epi0:
  v_add_f32 v96, v32, v33
  v_add_f32 v97, v34, v35
  v_add_f32 v98, v36, v37
  v_add_f32 v99, v38, v39
  v_add_f32 v96, v96, v97
  v_add_f32 v98, v98, v99
  v_mov_b32 v32, 0
  v_mov_b32 v33, 0
  v_mov_b32 v34, 0
  v_mov_b32 v35, 0
  v_mov_b32 v36, 0
  v_mov_b32 v37, 0
  v_mov_b32 v38, 0
  v_mov_b32 v39, 0
  v_cndmask_b32 v96, v96, v98, s[46:47]
  v_cvt_pk_bf16_f32 v96, v96, v96
  buffer_store_short v96, v20, s[12:15], 0 offen
  s_add_u32 s12, s12, 256
  s_addc_u32 s13, s13, 0
  s_branch LB_done0
LB_fepi0:
  v_add_f32 v96, v32, v33
  v_add_f32 v97, v34, v35
  v_add_f32 v98, v36, v37
  v_add_f32 v99, v38, v39
  v_add_f32 v96, v96, v97
  v_add_f32 v98, v98, v99
  v_mov_b32 v32, 0
  v_mov_b32 v33, 0
  v_mov_b32 v34, 0
  v_mov_b32 v35, 0
  v_mov_b32 v36, 0
  v_mov_b32 v37, 0
  v_mov_b32 v38, 0
  v_mov_b32 v39, 0
  v_cndmask_b32 v96, v96, v98, s[46:47]
  v_cvt_pk_bf16_f32 v96, v96, v96
  buffer_store_short v96, v20, s[12:15], 0 offen
  s_add_u32 s12, s12, 256
  s_addc_u32 s13, s13, 0
  s_branch LB_fdone0
LB_epi1:
  v_add_f32 v96, v32, v33
  v_add_f32 v97, v34, v35
  v_add_f32 v98, v36, v37
  v_add_f32 v99, v38, v39
  v_add_f32 v96, v96, v97
  v_add_f32 v98, v98, v99
  v_mov_b32 v32, 0
  v_mov_b32 v33, 0
  v_mov_b32 v34, 0
  v_mov_b32 v35, 0
  v_mov_b32 v36, 0
  v_mov_b32 v37, 0
  v_mov_b32 v38, 0
  v_mov_b32 v39, 0
  v_cndmask_b32 v96, v96, v98, s[46:47]
  v_cvt_pk_bf16_f32 v96, v96, v96
  buffer_store_short v96, v20, s[12:15], 0 offen
  s_add_u32 s12, s12, 256
  s_addc_u32 s13, s13, 0
  s_branch LB_done1
LB_fepi1:
  v_add_f32 v96, v32, v33
  v_add_f32 v97, v34, v35
  v_add_f32 v98, v36, v37
  v_add_f32 v99, v38, v39
  v_add_f32 v96, v96, v97
  v_add_f32 v98, v98, v99
  v_mov_b32 v32, 0
  v_mov_b32 v33, 0
  v_mov_b32 v34, 0
  v_mov_b32 v35, 0
  v_mov_b32 v36, 0
  v_mov_b32 v37, 0
  v_mov_b32 v38, 0
  v_mov_b32 v39, 0
  v_cndmask_b32 v96, v96, v98, s[46:47]
  v_cvt_pk_bf16_f32 v96, v96, v96
  buffer_store_short v96, v20, s[12:15], 0 offen
  s_add_u32 s12, s12, 256
  s_addc_u32 s13, s13, 0
  s_branch LB_fdone1
LB_epi2:
  v_add_f32 v96, v32, v33
  v_add_f32 v97, v34, v35
  v_add_f32 v98, v36, v37
  v_add_f32 v99, v38, v39
  v_add_f32 v96, v96, v97
  v_add_f32 v98, v98, v99
  v_mov_b32 v32, 0
  v_mov_b32 v33, 0
  v_mov_b32 v34, 0
  v_mov_b32 v35, 0
  v_mov_b32 v36, 0
  v_mov_b32 v37, 0
  v_mov_b32 v38, 0
  v_mov_b32 v39, 0
  v_cndmask_b32 v96, v96, v98, s[46:47]
  v_cvt_pk_bf16_f32 v96, v96, v96
  buffer_store_short v96, v20, s[12:15], 0 offen
  s_add_u32 s12, s12, 256
  s_addc_u32 s13, s13, 0
  s_branch LB_done2
LB_fepi2:
  v_add_f32 v96, v32, v33
  v_add_f32 v97, v34, v35
  v_add_f32 v98, v36, v37
  v_add_f32 v99, v38, v39
  v_add_f32 v96, v96, v97
  v_add_f32 v98, v98, v99
  v_mov_b32 v32, 0
  v_mov_b32 v33, 0
  v_mov_b32 v34, 0
  v_mov_b32 v35, 0
  v_mov_b32 v36, 0
  v_mov_b32 v37, 0
  v_mov_b32 v38, 0
  v_mov_b32 v39, 0
  v_cndmask_b32 v96, v96, v98, s[46:47]
  v_cvt_pk_bf16_f32 v96, v96, v96
  buffer_store_short v96, v20, s[12:15], 0 offen
  s_add_u32 s12, s12, 256
  s_addc_u32 s13, s13, 0
  s_branch LB_fdone2
LB_epi3:
  v_add_f32 v96, v32, v33
  v_add_f32 v97, v34, v35
  v_add_f32 v98, v36, v37
  v_add_f32 v99, v38, v39
  v_add_f32 v96, v96, v97
  v_add_f32 v98, v98, v99
  v_mov_b32 v32, 0
  v_mov_b32 v33, 0
  v_mov_b32 v34, 0
  v_mov_b32 v35, 0
  v_mov_b32 v36, 0
  v_mov_b32 v37, 0
  v_mov_b32 v38, 0
  v_mov_b32 v39, 0
  v_cndmask_b32 v96, v96, v98, s[46:47]
  v_cvt_pk_bf16_f32 v96, v96, v96
  buffer_store_short v96, v20, s[12:15], 0 offen
  s_add_u32 s12, s12, 256
  s_addc_u32 s13, s13, 0
  s_branch LB_done3
LB_fepi3:
  v_add_f32 v96, v32, v33
  v_add_f32 v97, v34, v35
  v_add_f32 v98, v36, v37
  v_add_f32 v99, v38, v39
  v_add_f32 v96, v96, v97
  v_add_f32 v98, v98, v99
  v_mov_b32 v32, 0
  v_mov_b32 v33, 0
  v_mov_b32 v34, 0
  v_mov_b32 v35, 0
  v_mov_b32 v36, 0
  v_mov_b32 v37, 0
  v_mov_b32 v38, 0
  v_mov_b32 v39, 0
  v_cndmask_b32 v96, v96, v98, s[46:47]
  v_cvt_pk_bf16_f32 v96, v96, v96
  buffer_store_short v96, v20, s[12:15], 0 offen
  s_add_u32 s12, s12, 256
  s_addc_u32 s13, s13, 0
  s_branch LB_fdone3
LB_epi4:
  v_add_f32 v96, v32, v33
  v_add_f32 v97, v34, v35
  v_add_f32 v98, v36, v37
  v_add_f32 v99, v38, v39
  v_add_f32 v96, v96, v97
  v_add_f32 v98, v98, v99
  v_mov_b32 v32, 0
  v_mov_b32 v33, 0
  v_mov_b32 v34, 0
  v_mov_b32 v35, 0
  v_mov_b32 v36, 0
  v_mov_b32 v37, 0
  v_mov_b32 v38, 0
  v_mov_b32 v39, 0
  v_cndmask_b32 v96, v96, v98, s[46:47]
  v_cvt_pk_bf16_f32 v96, v96, v96
  buffer_store_short v96, v20, s[12:15], 0 offen
  s_add_u32 s12, s12, 256
  s_addc_u32 s13, s13, 0
  s_branch LB_done4
LB_fepi4:
  v_add_f32 v96, v32, v33
  v_add_f32 v97, v34, v35
  v_add_f32 v98, v36, v37
  v_add_f32 v99, v38, v39
  v_add_f32 v96, v96, v97
  v_add_f32 v98, v98, v99
  v_mov_b32 v32, 0
  v_mov_b32 v33, 0
  v_mov_b32 v34, 0
  v_mov_b32 v35, 0
  v_mov_b32 v36, 0
  v_mov_b32 v37, 0
  v_mov_b32 v38, 0
  v_mov_b32 v39, 0
  v_cndmask_b32 v96, v96, v98, s[46:47]
  v_cvt_pk_bf16_f32 v96, v96, v96
  buffer_store_short v96, v20, s[12:15], 0 offen
  s_add_u32 s12, s12, 256
  s_addc_u32 s13, s13, 0
  s_branch LB_fdone4
LB_epi5:
  v_add_f32 v96, v32, v33
  v_add_f32 v97, v34, v35
  v_add_f32 v98, v36, v37
  v_add_f32 v99, v38, v39
  v_add_f32 v96, v96, v97
  v_add_f32 v98, v98, v99
  v_mov_b32 v32, 0
  v_mov_b32 v33, 0
  v_mov_b32 v34, 0
  v_mov_b32 v35, 0
  v_mov_b32 v36, 0
  v_mov_b32 v37, 0
  v_mov_b32 v38, 0
  v_mov_b32 v39, 0
  v_cndmask_b32 v96, v96, v98, s[46:47]
  v_cvt_pk_bf16_f32 v96, v96, v96
  buffer_store_short v96, v20, s[12:15], 0 offen
  s_add_u32 s12, s12, 256
  s_addc_u32 s13, s13, 0
  s_branch LB_done5
LB_fepi5:
  v_add_f32 v96, v32, v33
  v_add_f32 v97, v34, v35
  v_add_f32 v98, v36, v37
  v_add_f32 v99, v38, v39
  v_add_f32 v96, v96, v97
  v_add_f32 v98, v98, v99
  v_mov_b32 v32, 0
  v_mov_b32 v33, 0
  v_mov_b32 v34, 0
  v_mov_b32 v35, 0
  v_mov_b32 v36, 0
  v_mov_b32 v37, 0
  v_mov_b32 v38, 0
  v_mov_b32 v39, 0
  v_cndmask_b32 v96, v96, v98, s[46:47]
  v_cvt_pk_bf16_f32 v96, v96, v96
  buffer_store_short v96, v20, s[12:15], 0 offen
  s_add_u32 s12, s12, 256
  s_addc_u32 s13, s13, 0
  s_branch LB_fdone5
LB_epi6:
  v_add_f32 v96, v32, v33
  v_add_f32 v97, v34, v35
  v_add_f32 v98, v36, v37
  v_add_f32 v99, v38, v39
  v_add_f32 v96, v96, v97
  v_add_f32 v98, v98, v99
  v_mov_b32 v32, 0
  v_mov_b32 v33, 0
  v_mov_b32 v34, 0
  v_mov_b32 v35, 0
  v_mov_b32 v36, 0
  v_mov_b32 v37, 0
  v_mov_b32 v38, 0
  v_mov_b32 v39, 0
  v_cndmask_b32 v96, v96, v98, s[46:47]
  v_cvt_pk_bf16_f32 v96, v96, v96
  buffer_store_short v96, v20, s[12:15], 0 offen
  s_add_u32 s12, s12, 256
  s_addc_u32 s13, s13, 0
  s_branch LB_done6
LB_fepi6:
  v_add_f32 v96, v32, v33
  v_add_f32 v97, v34, v35
  v_add_f32 v98, v36, v37
  v_add_f32 v99, v38, v39
  v_add_f32 v96, v96, v97
  v_add_f32 v98, v98, v99
  v_mov_b32 v32, 0
  v_mov_b32 v33, 0
  v_mov_b32 v34, 0
  v_mov_b32 v35, 0
  v_mov_b32 v36, 0
  v_mov_b32 v37, 0
  v_mov_b32 v38, 0
  v_mov_b32 v39, 0
  v_cndmask_b32 v96, v96, v98, s[46:47]
  v_cvt_pk_bf16_f32 v96, v96, v96
  buffer_store_short v96, v20, s[12:15], 0 offen
  s_add_u32 s12, s12, 256
  s_addc_u32 s13, s13, 0
  s_branch LB_fdone6
LB_epi7:
  v_add_f32 v96, v32, v33
  v_add_f32 v97, v34, v35
  v_add_f32 v98, v36, v37
  v_add_f32 v99, v38, v39
  v_add_f32 v96, v96, v97
  v_add_f32 v98, v98, v99
  v_mov_b32 v32, 0
  v_mov_b32 v33, 0
  v_mov_b32 v34, 0
  v_mov_b32 v35, 0
  v_mov_b32 v36, 0
  v_mov_b32 v37, 0
  v_mov_b32 v38, 0
  v_mov_b32 v39, 0
  v_cndmask_b32 v96, v96, v98, s[46:47]
  v_cvt_pk_bf16_f32 v96, v96, v96
  buffer_store_short v96, v20, s[12:15], 0 offen
  s_add_u32 s12, s12, 256
  s_addc_u32 s13, s13, 0
  s_branch LB_done7
LB_fepi7:
  v_add_f32 v96, v32, v33
  v_add_f32 v97, v34, v35
  v_add_f32 v98, v36, v37
  v_add_f32 v99, v38, v39
  v_add_f32 v96, v96, v97
  v_add_f32 v98, v98, v99
  v_mov_b32 v32, 0
  v_mov_b32 v33, 0
  v_mov_b32 v34, 0
  v_mov_b32 v35, 0
  v_mov_b32 v36, 0
  v_mov_b32 v37, 0
  v_mov_b32 v38, 0
  v_mov_b32 v39, 0
  v_cndmask_b32 v96, v96, v98, s[46:47]
  v_cvt_pk_bf16_f32 v96, v96, v96
  buffer_store_short v96, v20, s[12:15], 0 offen
  s_add_u32 s12, s12, 256
  s_addc_u32 s13, s13, 0
  s_branch LB_fdone7
LB_slow0:
  s_cmp_eq_u32 s93, -1
  s_cbranch_scc1 LB_stub0
LB_spin0:
  ds_read_b32 v21, v15 offset:512
  s_waitcnt lgkmcnt(0)
  v_readfirstlane_b32 s55, v21
s_nop 0
  s_cmp_ge_u32 s55, s93
  s_cbranch_scc0 LB_spin0
  s_branch LB_b1
LB_slow1:
  s_cmp_eq_u32 s93, -1
  s_cbranch_scc1 LB_stub1
LB_spin1:
  ds_read_b32 v21, v15 offset:512
  s_waitcnt lgkmcnt(0)
  v_readfirstlane_b32 s55, v21
s_nop 0
  s_cmp_ge_u32 s55, s93
  s_cbranch_scc0 LB_spin1
  s_branch LB_b2
LB_slow2:
  s_cmp_eq_u32 s93, -1
  s_cbranch_scc1 LB_stub2
LB_spin2:
  ds_read_b32 v21, v15 offset:512
  s_waitcnt lgkmcnt(0)
  v_readfirstlane_b32 s55, v21
s_nop 0
  s_cmp_ge_u32 s55, s93
  s_cbranch_scc0 LB_spin2
  s_branch LB_b3
LB_slow3:
  s_cmp_eq_u32 s93, -1
  s_cbranch_scc1 LB_stub3
LB_spin3:
  ds_read_b32 v21, v15 offset:512
  s_waitcnt lgkmcnt(0)
  v_readfirstlane_b32 s55, v21
s_nop 0
  s_cmp_ge_u32 s55, s93
  s_cbranch_scc0 LB_spin3
  s_branch LB_b4
LB_slow4:
  s_cmp_eq_u32 s93, -1
  s_cbranch_scc1 LB_stub4
LB_spin4:
  ds_read_b32 v21, v15 offset:512
  s_waitcnt lgkmcnt(0)
  v_readfirstlane_b32 s55, v21
s_nop 0
  s_cmp_ge_u32 s55, s93
  s_cbranch_scc0 LB_spin4
  s_branch LB_b5
LB_slow5:
  s_cmp_eq_u32 s93, -1
  s_cbranch_scc1 LB_stub5
LB_spin5:
  ds_read_b32 v21, v15 offset:512
  s_waitcnt lgkmcnt(0)
  v_readfirstlane_b32 s55, v21
s_nop 0
  s_cmp_ge_u32 s55, s93
  s_cbranch_scc0 LB_spin5
  s_branch LB_b6
LB_slow6:
  s_cmp_eq_u32 s93, -1
  s_cbranch_scc1 LB_stub6
LB_spin6:
  ds_read_b32 v21, v15 offset:512
  s_waitcnt lgkmcnt(0)
  v_readfirstlane_b32 s55, v21
s_nop 0
  s_cmp_ge_u32 s55, s93
  s_cbranch_scc0 LB_spin6
  s_branch LB_b7
LB_slow7:
  s_cmp_eq_u32 s93, -1
  s_cbranch_scc1 LB_stub7
LB_spin7:
  ds_read_b32 v21, v15 offset:512
  s_waitcnt lgkmcnt(0)
  v_readfirstlane_b32 s55, v21
s_nop 0
  s_cmp_ge_u32 s55, s93
  s_cbranch_scc0 LB_spin7
  s_branch LB_b0
LB_stub0:
  s_mov_b32 s50, 57344
  s_mov_b32 s51, 0
  s_mov_b32 s53, 256
  s_mov_b32 s54, 0
  s_lshr_b64 s[42:43], s[42:43], 1
  s_branch L_tail
LB_stub1:
  s_mov_b32 s50, 0
  s_mov_b32 s51, 8192
  s_mov_b32 s53, 0
  s_mov_b32 s54, 256
  s_lshr_b64 s[42:43], s[42:43], 2
  s_branch L_tail
LB_stub2:
  s_mov_b32 s50, 8192
  s_mov_b32 s51, 16384
  s_mov_b32 s53, 256
  s_mov_b32 s54, 0
  s_lshr_b64 s[42:43], s[42:43], 3
  s_branch L_tail
LB_stub3:
  s_mov_b32 s50, 16384
  s_mov_b32 s51, 24576
  s_mov_b32 s53, 0
  s_mov_b32 s54, 256
  s_lshr_b64 s[42:43], s[42:43], 4
  s_branch L_tail
LB_stub4:
  s_mov_b32 s50, 24576
  s_mov_b32 s51, 32768
  s_mov_b32 s53, 256
  s_mov_b32 s54, 0
  s_lshr_b64 s[42:43], s[42:43], 5
  s_branch L_tail
LB_stub5:
  s_mov_b32 s50, 32768
  s_mov_b32 s51, 40960
  s_mov_b32 s53, 0
  s_mov_b32 s54, 256
  s_lshr_b64 s[42:43], s[42:43], 6
  s_branch L_tail
LB_stub6:
  s_mov_b32 s50, 40960
  s_mov_b32 s51, 49152
  s_mov_b32 s53, 256
  s_mov_b32 s54, 0
  s_lshr_b64 s[42:43], s[42:43], 7
  s_branch L_tail
LB_stub7:
  s_mov_b32 s50, 49152
  s_mov_b32 s51, 57344
  s_mov_b32 s53, 0
  s_mov_b32 s54, 256
  s_branch L_tail
LA_entry:
  s_setprio 3
LA_b0:
  ds_read_b128 v[96:99], v0 offset:0
  ds_read_b128 v[100:103], v1 offset:0
  ds_read_b128 v[104:107], v2 offset:0
  ds_read_b128 v[108:111], v3 offset:0
  v_mfma_f32_16x16x32_bf16 v[28:31], v[40:43], v[64:67], v[22:25]
  ds_read_b128 v[112:115], v0 offset:4096
  ds_read_b128 v[116:119], v1 offset:4096
  v_mfma_f32_16x16x32_bf16 v[28:31], v[44:47], v[68:71], v[28:31]
  ds_read_b128 v[120:123], v2 offset:4096
  ds_read_b128 v[124:127], v3 offset:4096
  v_lshl_add_u32 v21, v9, 8, v10
  s_add_u32 m0, s37, 40960
  ds_read_b128 v[88:91], v15 offset:0
  buffer_load_dwordx4 v21, s[4:7], 0 offen nt lds
  s_waitcnt lgkmcnt(8)
  v_mfma_f32_32x32x16_bf16 v[64:79], v[224:227], v[96:99], v[48:63]
  v_mul_f32 v28, v28, v12
  v_mul_f32 v29, v29, v13
  v_cvt_pk_bf16_f32 v28, v28, v29
  ds_write_b32 v14, v28 offset:256
  s_waitcnt lgkmcnt(8)
  v_mfma_f32_32x32x16_bf16 v[64:79], v[228:231], v[100:103], v[64:79]
  s_add_u32 m0, s37, 44928
  ds_read_b64_tr_b16 v[80:81], v4 offset:49152
  buffer_load_dwordx4 v21, s[4:7], 0 offen offset:128 nt lds
  ds_read_b64_tr_b16 v[82:83], v6 offset:49152
  s_waitcnt lgkmcnt(9)
  v_mfma_f32_32x32x16_bf16 v[64:79], v[232:235], v[104:107], v[64:79]
  ds_read_b64_tr_b16 v[84:85], v5 offset:49152
  ds_read_b64_tr_b16 v[86:87], v7 offset:49152
  ds_read_u16 v9, v8 offset:384
  s_waitcnt lgkmcnt(11)
  v_mfma_f32_32x32x16_bf16 v[64:79], v[236:239], v[108:111], v[64:79]
  ds_read_u16_d16_hi v12, v11 offset:64
  ds_read_u16_d16_hi v13, v11 offset:96
  s_add_u32 s92, s92, 4
  s_bitcmp1_b32 s34, 0
  s_cselect_b32 s93, -1, s92
  s_waitcnt lgkmcnt(12)
  v_mfma_f32_32x32x16_bf16 v[64:79], v[240:243], v[112:115], v[64:79]
  s_waitcnt lgkmcnt(11)
  v_mfma_f32_32x32x16_bf16 v[64:79], v[244:247], v[116:119], v[64:79]
  s_waitcnt lgkmcnt(10)
  v_mfma_f32_32x32x16_bf16 v[64:79], v[248:251], v[120:123], v[64:79]
  s_waitcnt lgkmcnt(9)
  v_mfma_f32_32x32x16_bf16 v[64:79], v[252:255], v[124:127], v[64:79]
  s_waitcnt lgkmcnt(5)
  v_mfma_f32_16x16x32_bf16 v[32:35], v[88:91], v[80:83], v[32:35]
  s_waitcnt lgkmcnt(3)
  v_mfma_f32_16x16x32_bf16 v[36:39], v[88:91], v[84:87], v[36:39]
  s_bitcmp1_b32 s40, 1
  s_cbranch_scc1 LA_first0
  s_bitcmp1_b32 s42, 0
  s_waitcnt vmcnt(8)
  s_mov_b64 exec, 1
  ds_inc_u32 v15, v15 offset:512
  s_mov_b64 exec, -1
  s_cbranch_scc1 LA_epi0
LA_done0:
  s_setprio 1
  v_exp_f32 v64, v64
  v_exp_f32 v65, v65
  v_exp_f32 v66, v66
  v_exp_f32 v67, v67
  v_exp_f32 v68, v68
  v_exp_f32 v69, v69
  v_exp_f32 v70, v70
  v_exp_f32 v71, v71
  v_exp_f32 v72, v72
  v_exp_f32 v73, v73
  v_exp_f32 v74, v74
  v_exp_f32 v75, v75
  v_exp_f32 v76, v76
  v_exp_f32 v77, v77
  v_exp_f32 v78, v78
  v_exp_f32 v79, v79
  v_add_f32 v64, 1.0, v64
  v_add_f32 v65, 1.0, v65
  v_add_f32 v66, 1.0, v66
  v_add_f32 v67, 1.0, v67
  v_add_f32 v68, 1.0, v68
  v_add_f32 v69, 1.0, v69
  v_add_f32 v70, 1.0, v70
  v_add_f32 v71, 1.0, v71
  s_setprio 2
  v_add_f32 v72, 1.0, v72
  v_add_f32 v73, 1.0, v73
  v_add_f32 v74, 1.0, v74
  v_add_f32 v75, 1.0, v75
  v_add_f32 v76, 1.0, v76
  v_add_f32 v77, 1.0, v77
  v_add_f32 v78, 1.0, v78
  v_add_f32 v79, 1.0, v79
  v_rcp_f32 v64, v64
  v_rcp_f32 v65, v65
  v_rcp_f32 v66, v66
  v_rcp_f32 v67, v67
  v_rcp_f32 v68, v68
  v_rcp_f32 v69, v69
  v_rcp_f32 v70, v70
  v_rcp_f32 v71, v71
  v_cvt_pk_bf16_f32 v64, v64, v65
  v_cvt_pk_bf16_f32 v65, v66, v67
  v_cvt_pk_bf16_f32 v66, v68, v69
  v_cvt_pk_bf16_f32 v67, v70, v71
  v_rcp_f32 v72, v72
  v_rcp_f32 v73, v73
  ds_read_b32 v21, v15 offset:512
  v_rcp_f32 v74, v74
  v_rcp_f32 v75, v75
  v_rcp_f32 v76, v76
  v_rcp_f32 v77, v77
  v_rcp_f32 v78, v78
  v_rcp_f32 v79, v79
  v_cvt_pk_bf16_f32 v68, v72, v73
  v_cvt_pk_bf16_f32 v69, v74, v75
  v_cvt_pk_bf16_f32 v70, v76, v77
  v_cvt_pk_bf16_f32 v71, v78, v79
LA_vj0:
  s_waitcnt lgkmcnt(0)
  v_readfirstlane_b32 s55, v21
  s_setprio 3
  s_cmp_ge_u32 s55, s93
  s_cbranch_scc0 LA_slow0
LA_b1:
  ds_read_b128 v[96:99], v0 offset:8192
  ds_read_b128 v[100:103], v1 offset:8192
  ds_read_b128 v[104:107], v2 offset:8192
  ds_read_b128 v[108:111], v3 offset:8192
  v_mfma_f32_16x16x32_bf16 v[28:31], v[40:43], v[64:67], v[22:25]
  ds_read_b128 v[112:115], v0 offset:12288
  ds_read_b128 v[116:119], v1 offset:12288
  v_mfma_f32_16x16x32_bf16 v[28:31], v[44:47], v[68:71], v[28:31]
  ds_read_b128 v[120:123], v2 offset:12288
  ds_read_b128 v[124:127], v3 offset:12288
  v_lshl_add_u32 v21, v9, 8, v10
  s_add_u32 m0, s37, 49152
  ds_read_b128 v[88:91], v15 offset:256
  buffer_load_dwordx4 v21, s[4:7], 0 offen nt lds
  s_waitcnt lgkmcnt(8)
  v_mfma_f32_32x32x16_bf16 v[64:79], v[224:227], v[96:99], v[48:63]
  v_mul_f32 v28, v28, v12
  v_mul_f32 v29, v29, v13
  v_cvt_pk_bf16_f32 v28, v28, v29
  ds_write_b32 v14, v28 offset:0
  s_waitcnt lgkmcnt(8)
  v_mfma_f32_32x32x16_bf16 v[64:79], v[228:231], v[100:103], v[64:79]
  s_add_u32 m0, s37, 53120
  ds_read_b64_tr_b16 v[80:81], v4 offset:57344
  buffer_load_dwordx4 v21, s[4:7], 0 offen offset:128 nt lds
  ds_read_b64_tr_b16 v[82:83], v6 offset:57344
  s_waitcnt lgkmcnt(9)
  v_mfma_f32_32x32x16_bf16 v[64:79], v[232:235], v[104:107], v[64:79]
  ds_read_b64_tr_b16 v[84:85], v5 offset:57344
  ds_read_b64_tr_b16 v[86:87], v7 offset:57344
  ds_read_u16 v9, v8 offset:448
  s_waitcnt lgkmcnt(11)
  v_mfma_f32_32x32x16_bf16 v[64:79], v[236:239], v[108:111], v[64:79]
  ds_read_u16_d16_hi v12, v11 offset:128
  ds_read_u16_d16_hi v13, v11 offset:160
  s_add_u32 s92, s92, 4
  s_bitcmp1_b32 s34, 1
  s_cselect_b32 s93, -1, s92
  s_waitcnt lgkmcnt(12)
  v_mfma_f32_32x32x16_bf16 v[64:79], v[240:243], v[112:115], v[64:79]
  s_waitcnt lgkmcnt(11)
  v_mfma_f32_32x32x16_bf16 v[64:79], v[244:247], v[116:119], v[64:79]
  s_waitcnt lgkmcnt(10)
  v_mfma_f32_32x32x16_bf16 v[64:79], v[248:251], v[120:123], v[64:79]
  s_waitcnt lgkmcnt(9)
  v_mfma_f32_32x32x16_bf16 v[64:79], v[252:255], v[124:127], v[64:79]
  s_waitcnt lgkmcnt(5)
  v_mfma_f32_16x16x32_bf16 v[32:35], v[88:91], v[80:83], v[32:35]
  s_waitcnt lgkmcnt(3)
  v_mfma_f32_16x16x32_bf16 v[36:39], v[88:91], v[84:87], v[36:39]
  s_bitcmp1_b32 s40, 2
  s_cbranch_scc1 LA_first1
  s_bitcmp1_b32 s42, 1
  s_waitcnt vmcnt(8)
  s_mov_b64 exec, 1
  ds_inc_u32 v15, v15 offset:512
  s_mov_b64 exec, -1
  s_cbranch_scc1 LA_epi1
LA_done1:
  s_setprio 1
  v_exp_f32 v64, v64
  v_exp_f32 v65, v65
  v_exp_f32 v66, v66
  v_exp_f32 v67, v67
  v_exp_f32 v68, v68
  v_exp_f32 v69, v69
  v_exp_f32 v70, v70
  v_exp_f32 v71, v71
  v_exp_f32 v72, v72
  v_exp_f32 v73, v73
  v_exp_f32 v74, v74
  v_exp_f32 v75, v75
  v_exp_f32 v76, v76
  v_exp_f32 v77, v77
  v_exp_f32 v78, v78
  v_exp_f32 v79, v79
  v_add_f32 v64, 1.0, v64
  v_add_f32 v65, 1.0, v65
  v_add_f32 v66, 1.0, v66
  v_add_f32 v67, 1.0, v67
  v_add_f32 v68, 1.0, v68
  v_add_f32 v69, 1.0, v69
  v_add_f32 v70, 1.0, v70
  v_add_f32 v71, 1.0, v71
  s_setprio 2
  v_add_f32 v72, 1.0, v72
  v_add_f32 v73, 1.0, v73
  v_add_f32 v74, 1.0, v74
  v_add_f32 v75, 1.0, v75
  v_add_f32 v76, 1.0, v76
  v_add_f32 v77, 1.0, v77
  v_add_f32 v78, 1.0, v78
  v_add_f32 v79, 1.0, v79
  v_rcp_f32 v64, v64
  v_rcp_f32 v65, v65
  v_rcp_f32 v66, v66
  v_rcp_f32 v67, v67
  v_rcp_f32 v68, v68
  v_rcp_f32 v69, v69
  v_rcp_f32 v70, v70
  v_rcp_f32 v71, v71
  v_cvt_pk_bf16_f32 v64, v64, v65
  v_cvt_pk_bf16_f32 v65, v66, v67
  v_cvt_pk_bf16_f32 v66, v68, v69
  v_cvt_pk_bf16_f32 v67, v70, v71
  v_rcp_f32 v72, v72
  v_rcp_f32 v73, v73
  ds_read_b32 v21, v15 offset:512
  v_rcp_f32 v74, v74
  v_rcp_f32 v75, v75
  v_rcp_f32 v76, v76
  v_rcp_f32 v77, v77
  v_rcp_f32 v78, v78
  v_rcp_f32 v79, v79
  v_cvt_pk_bf16_f32 v68, v72, v73
  v_cvt_pk_bf16_f32 v69, v74, v75
  v_cvt_pk_bf16_f32 v70, v76, v77
  v_cvt_pk_bf16_f32 v71, v78, v79
LA_vj1:
  s_waitcnt lgkmcnt(0)
  v_readfirstlane_b32 s55, v21
  s_setprio 3
  s_cmp_ge_u32 s55, s93
  s_cbranch_scc0 LA_slow1
LA_b2:
  ds_read_b128 v[96:99], v0 offset:16384
  ds_read_b128 v[100:103], v1 offset:16384
  ds_read_b128 v[104:107], v2 offset:16384
  ds_read_b128 v[108:111], v3 offset:16384
  v_mfma_f32_16x16x32_bf16 v[28:31], v[40:43], v[64:67], v[22:25]
  ds_read_b128 v[112:115], v0 offset:20480
  ds_read_b128 v[116:119], v1 offset:20480
  v_mfma_f32_16x16x32_bf16 v[28:31], v[44:47], v[68:71], v[28:31]
  ds_read_b128 v[120:123], v2 offset:20480
  ds_read_b128 v[124:127], v3 offset:20480
  v_lshl_add_u32 v21, v9, 8, v10
  s_add_u32 m0, s37, 57344
  ds_read_b128 v[88:91], v15 offset:0
  buffer_load_dwordx4 v21, s[4:7], 0 offen nt lds
  s_waitcnt lgkmcnt(8)
  v_mfma_f32_32x32x16_bf16 v[64:79], v[224:227], v[96:99], v[48:63]
  v_mul_f32 v28, v28, v12
  v_mul_f32 v29, v29, v13
  v_cvt_pk_bf16_f32 v28, v28, v29
  ds_write_b32 v14, v28 offset:256
  s_waitcnt lgkmcnt(8)
  v_mfma_f32_32x32x16_bf16 v[64:79], v[228:231], v[100:103], v[64:79]
  s_add_u32 m0, s37, 61312
  ds_read_b64_tr_b16 v[80:81], v4 offset:0
  buffer_load_dwordx4 v21, s[4:7], 0 offen offset:128 nt lds
  ds_read_b64_tr_b16 v[82:83], v6 offset:0
  s_waitcnt lgkmcnt(9)
  v_mfma_f32_32x32x16_bf16 v[64:79], v[232:235], v[104:107], v[64:79]
  ds_read_b64_tr_b16 v[84:85], v5 offset:0
  ds_read_b64_tr_b16 v[86:87], v7 offset:0
  ds_read_u16 v9, v8 offset:512
  s_waitcnt lgkmcnt(11)
  v_mfma_f32_32x32x16_bf16 v[64:79], v[236:239], v[108:111], v[64:79]
  ds_read_u16_d16_hi v12, v11 offset:192
  ds_read_u16_d16_hi v13, v11 offset:224
  s_add_u32 s92, s92, 4
  s_bitcmp1_b32 s34, 2
  s_cselect_b32 s93, -1, s92
  s_waitcnt lgkmcnt(12)
  v_mfma_f32_32x32x16_bf16 v[64:79], v[240:243], v[112:115], v[64:79]
  s_waitcnt lgkmcnt(11)
  v_mfma_f32_32x32x16_bf16 v[64:79], v[244:247], v[116:119], v[64:79]
  s_waitcnt lgkmcnt(10)
  v_mfma_f32_32x32x16_bf16 v[64:79], v[248:251], v[120:123], v[64:79]
  s_waitcnt lgkmcnt(9)
  v_mfma_f32_32x32x16_bf16 v[64:79], v[252:255], v[124:127], v[64:79]
  s_waitcnt lgkmcnt(5)
  v_mfma_f32_16x16x32_bf16 v[32:35], v[88:91], v[80:83], v[32:35]
  s_waitcnt lgkmcnt(3)
  v_mfma_f32_16x16x32_bf16 v[36:39], v[88:91], v[84:87], v[36:39]
  s_bitcmp1_b32 s40, 3
  s_cbranch_scc1 LA_first2
  s_bitcmp1_b32 s42, 2
  s_waitcnt vmcnt(8)
  s_mov_b64 exec, 1
  ds_inc_u32 v15, v15 offset:512
  s_mov_b64 exec, -1
  s_cbranch_scc1 LA_epi2
LA_done2:
  s_setprio 1
  v_exp_f32 v64, v64
  v_exp_f32 v65, v65
  v_exp_f32 v66, v66
  v_exp_f32 v67, v67
  v_exp_f32 v68, v68
  v_exp_f32 v69, v69
  v_exp_f32 v70, v70
  v_exp_f32 v71, v71
  v_exp_f32 v72, v72
  v_exp_f32 v73, v73
  v_exp_f32 v74, v74
  v_exp_f32 v75, v75
  v_exp_f32 v76, v76
  v_exp_f32 v77, v77
  v_exp_f32 v78, v78
  v_exp_f32 v79, v79
  v_add_f32 v64, 1.0, v64
  v_add_f32 v65, 1.0, v65
  v_add_f32 v66, 1.0, v66
  v_add_f32 v67, 1.0, v67
  v_add_f32 v68, 1.0, v68
  v_add_f32 v69, 1.0, v69
  v_add_f32 v70, 1.0, v70
  v_add_f32 v71, 1.0, v71
  s_setprio 2
  v_add_f32 v72, 1.0, v72
  v_add_f32 v73, 1.0, v73
  v_add_f32 v74, 1.0, v74
  v_add_f32 v75, 1.0, v75
  v_add_f32 v76, 1.0, v76
  v_add_f32 v77, 1.0, v77
  v_add_f32 v78, 1.0, v78
  v_add_f32 v79, 1.0, v79
  v_rcp_f32 v64, v64
  v_rcp_f32 v65, v65
  v_rcp_f32 v66, v66
  v_rcp_f32 v67, v67
  v_rcp_f32 v68, v68
  v_rcp_f32 v69, v69
  v_rcp_f32 v70, v70
  v_rcp_f32 v71, v71
  v_cvt_pk_bf16_f32 v64, v64, v65
  v_cvt_pk_bf16_f32 v65, v66, v67
  v_cvt_pk_bf16_f32 v66, v68, v69
  v_cvt_pk_bf16_f32 v67, v70, v71
  v_rcp_f32 v72, v72
  v_rcp_f32 v73, v73
  ds_read_b32 v21, v15 offset:512
  v_rcp_f32 v74, v74
  v_rcp_f32 v75, v75
  v_rcp_f32 v76, v76
  v_rcp_f32 v77, v77
  v_rcp_f32 v78, v78
  v_rcp_f32 v79, v79
  v_cvt_pk_bf16_f32 v68, v72, v73
  v_cvt_pk_bf16_f32 v69, v74, v75
  v_cvt_pk_bf16_f32 v70, v76, v77
  v_cvt_pk_bf16_f32 v71, v78, v79
LA_vj2:
  s_waitcnt lgkmcnt(0)
  v_readfirstlane_b32 s55, v21
  s_setprio 3
  s_cmp_ge_u32 s55, s93
  s_cbranch_scc0 LA_slow2
LA_b3:
  ds_read_b128 v[96:99], v0 offset:24576
  ds_read_b128 v[100:103], v1 offset:24576
  ds_read_b128 v[104:107], v2 offset:24576
  ds_read_b128 v[108:111], v3 offset:24576
  v_mfma_f32_16x16x32_bf16 v[28:31], v[40:43], v[64:67], v[22:25]
  ds_read_b128 v[112:115], v0 offset:28672
  ds_read_b128 v[116:119], v1 offset:28672
  v_mfma_f32_16x16x32_bf16 v[28:31], v[44:47], v[68:71], v[28:31]
  ds_read_b128 v[120:123], v2 offset:28672
  ds_read_b128 v[124:127], v3 offset:28672
  v_lshl_add_u32 v21, v9, 8, v10
  s_add_u32 m0, s37, 0
  ds_read_b128 v[88:91], v15 offset:256
  buffer_load_dwordx4 v21, s[4:7], 0 offen nt lds
  s_waitcnt lgkmcnt(8)
  v_mfma_f32_32x32x16_bf16 v[64:79], v[224:227], v[96:99], v[48:63]
  v_mul_f32 v28, v28, v12
  v_mul_f32 v29, v29, v13
  v_cvt_pk_bf16_f32 v28, v28, v29
  ds_write_b32 v14, v28 offset:0
  s_waitcnt lgkmcnt(8)
  v_mfma_f32_32x32x16_bf16 v[64:79], v[228:231], v[100:103], v[64:79]
  s_add_u32 m0, s37, 3968
  ds_read_b64_tr_b16 v[80:81], v4 offset:8192
  buffer_load_dwordx4 v21, s[4:7], 0 offen offset:128 nt lds
  ds_read_b64_tr_b16 v[82:83], v6 offset:8192
  s_waitcnt lgkmcnt(9)
  v_mfma_f32_32x32x16_bf16 v[64:79], v[232:235], v[104:107], v[64:79]
  ds_read_b64_tr_b16 v[84:85], v5 offset:8192
  ds_read_b64_tr_b16 v[86:87], v7 offset:8192
  ds_read_u16 v9, v8 offset:576
  s_waitcnt lgkmcnt(11)
  v_mfma_f32_32x32x16_bf16 v[64:79], v[236:239], v[108:111], v[64:79]
  ds_read_u16_d16_hi v12, v11 offset:256
  ds_read_u16_d16_hi v13, v11 offset:288
  s_add_u32 s92, s92, 4
  s_bitcmp1_b32 s34, 3
  s_cselect_b32 s93, -1, s92
  s_waitcnt lgkmcnt(12)
  v_mfma_f32_32x32x16_bf16 v[64:79], v[240:243], v[112:115], v[64:79]
  s_waitcnt lgkmcnt(11)
  v_mfma_f32_32x32x16_bf16 v[64:79], v[244:247], v[116:119], v[64:79]
  s_waitcnt lgkmcnt(10)
  v_mfma_f32_32x32x16_bf16 v[64:79], v[248:251], v[120:123], v[64:79]
  s_waitcnt lgkmcnt(9)
  v_mfma_f32_32x32x16_bf16 v[64:79], v[252:255], v[124:127], v[64:79]
  s_waitcnt lgkmcnt(5)
  v_mfma_f32_16x16x32_bf16 v[32:35], v[88:91], v[80:83], v[32:35]
  s_waitcnt lgkmcnt(3)
  v_mfma_f32_16x16x32_bf16 v[36:39], v[88:91], v[84:87], v[36:39]
  s_bitcmp1_b32 s40, 4
  s_cbranch_scc1 LA_first3
  s_bitcmp1_b32 s42, 3
  s_waitcnt vmcnt(8)
  s_mov_b64 exec, 1
  ds_inc_u32 v15, v15 offset:512
  s_mov_b64 exec, -1
  s_cbranch_scc1 LA_epi3
LA_done3:
  s_setprio 1
  v_exp_f32 v64, v64
  v_exp_f32 v65, v65
  v_exp_f32 v66, v66
  v_exp_f32 v67, v67
  v_exp_f32 v68, v68
  v_exp_f32 v69, v69
  v_exp_f32 v70, v70
  v_exp_f32 v71, v71
  v_exp_f32 v72, v72
  v_exp_f32 v73, v73
  v_exp_f32 v74, v74
  v_exp_f32 v75, v75
  v_exp_f32 v76, v76
  v_exp_f32 v77, v77
  v_exp_f32 v78, v78
  v_exp_f32 v79, v79
  v_add_f32 v64, 1.0, v64
  v_add_f32 v65, 1.0, v65
  v_add_f32 v66, 1.0, v66
  v_add_f32 v67, 1.0, v67
  v_add_f32 v68, 1.0, v68
  v_add_f32 v69, 1.0, v69
  v_add_f32 v70, 1.0, v70
  v_add_f32 v71, 1.0, v71
  s_setprio 2
  v_add_f32 v72, 1.0, v72
  v_add_f32 v73, 1.0, v73
  v_add_f32 v74, 1.0, v74
  v_add_f32 v75, 1.0, v75
  v_add_f32 v76, 1.0, v76
  v_add_f32 v77, 1.0, v77
  v_add_f32 v78, 1.0, v78
  v_add_f32 v79, 1.0, v79
  v_rcp_f32 v64, v64
  v_rcp_f32 v65, v65
  v_rcp_f32 v66, v66
  v_rcp_f32 v67, v67
  v_rcp_f32 v68, v68
  v_rcp_f32 v69, v69
  v_rcp_f32 v70, v70
  v_rcp_f32 v71, v71
  v_cvt_pk_bf16_f32 v64, v64, v65
  v_cvt_pk_bf16_f32 v65, v66, v67
  v_cvt_pk_bf16_f32 v66, v68, v69
  v_cvt_pk_bf16_f32 v67, v70, v71
  v_rcp_f32 v72, v72
  v_rcp_f32 v73, v73
  ds_read_b32 v21, v15 offset:512
  v_rcp_f32 v74, v74
  v_rcp_f32 v75, v75
  v_rcp_f32 v76, v76
  v_rcp_f32 v77, v77
  v_rcp_f32 v78, v78
  v_rcp_f32 v79, v79
  v_cvt_pk_bf16_f32 v68, v72, v73
  v_cvt_pk_bf16_f32 v69, v74, v75
  v_cvt_pk_bf16_f32 v70, v76, v77
  v_cvt_pk_bf16_f32 v71, v78, v79
LA_vj3:
  s_waitcnt lgkmcnt(0)
  v_readfirstlane_b32 s55, v21
  s_setprio 3
  s_cmp_ge_u32 s55, s93
  s_cbranch_scc0 LA_slow3
LA_b4:
  ds_read_b128 v[96:99], v0 offset:32768
  ds_read_b128 v[100:103], v1 offset:32768
  ds_read_b128 v[104:107], v2 offset:32768
  ds_read_b128 v[108:111], v3 offset:32768
  v_mfma_f32_16x16x32_bf16 v[28:31], v[40:43], v[64:67], v[22:25]
  ds_read_b128 v[112:115], v0 offset:36864
  ds_read_b128 v[116:119], v1 offset:36864
  v_mfma_f32_16x16x32_bf16 v[28:31], v[44:47], v[68:71], v[28:31]
  ds_read_b128 v[120:123], v2 offset:36864
  ds_read_b128 v[124:127], v3 offset:36864
  v_lshl_add_u32 v21, v9, 8, v10
  s_add_u32 m0, s37, 8192
  ds_read_b128 v[88:91], v15 offset:0
  buffer_load_dwordx4 v21, s[4:7], 0 offen nt lds
  s_waitcnt lgkmcnt(8)
  v_mfma_f32_32x32x16_bf16 v[64:79], v[224:227], v[96:99], v[48:63]
  v_mul_f32 v28, v28, v12
  v_mul_f32 v29, v29, v13
  v_cvt_pk_bf16_f32 v28, v28, v29
  ds_write_b32 v14, v28 offset:256
  s_waitcnt lgkmcnt(8)
  v_mfma_f32_32x32x16_bf16 v[64:79], v[228:231], v[100:103], v[64:79]
  s_add_u32 m0, s37, 12160
  ds_read_b64_tr_b16 v[80:81], v4 offset:16384
  buffer_load_dwordx4 v21, s[4:7], 0 offen offset:128 nt lds
  ds_read_b64_tr_b16 v[82:83], v6 offset:16384
  s_waitcnt lgkmcnt(9)
  v_mfma_f32_32x32x16_bf16 v[64:79], v[232:235], v[104:107], v[64:79]
  ds_read_b64_tr_b16 v[84:85], v5 offset:16384
  ds_read_b64_tr_b16 v[86:87], v7 offset:16384
  ds_read_u16 v9, v8 offset:640
  s_waitcnt lgkmcnt(11)
  v_mfma_f32_32x32x16_bf16 v[64:79], v[236:239], v[108:111], v[64:79]
  ds_read_u16_d16_hi v12, v11 offset:320
  ds_read_u16_d16_hi v13, v11 offset:352
  s_add_u32 s92, s92, 4
  s_bitcmp1_b32 s34, 4
  s_cselect_b32 s93, -1, s92
  s_waitcnt lgkmcnt(12)
  v_mfma_f32_32x32x16_bf16 v[64:79], v[240:243], v[112:115], v[64:79]
  s_waitcnt lgkmcnt(11)
  v_mfma_f32_32x32x16_bf16 v[64:79], v[244:247], v[116:119], v[64:79]
  s_waitcnt lgkmcnt(10)
  v_mfma_f32_32x32x16_bf16 v[64:79], v[248:251], v[120:123], v[64:79]
  s_waitcnt lgkmcnt(9)
  v_mfma_f32_32x32x16_bf16 v[64:79], v[252:255], v[124:127], v[64:79]
  s_waitcnt lgkmcnt(5)
  v_mfma_f32_16x16x32_bf16 v[32:35], v[88:91], v[80:83], v[32:35]
  s_waitcnt lgkmcnt(3)
  v_mfma_f32_16x16x32_bf16 v[36:39], v[88:91], v[84:87], v[36:39]
  s_bitcmp1_b32 s40, 5
  s_cbranch_scc1 LA_first4
  s_bitcmp1_b32 s42, 4
  s_waitcnt vmcnt(8)
  s_mov_b64 exec, 1
  ds_inc_u32 v15, v15 offset:512
  s_mov_b64 exec, -1
  s_cbranch_scc1 LA_epi4
LA_done4:
  s_setprio 1
  v_exp_f32 v64, v64
  v_exp_f32 v65, v65
  v_exp_f32 v66, v66
  v_exp_f32 v67, v67
  v_exp_f32 v68, v68
  v_exp_f32 v69, v69
  v_exp_f32 v70, v70
  v_exp_f32 v71, v71
  v_exp_f32 v72, v72
  v_exp_f32 v73, v73
  v_exp_f32 v74, v74
  v_exp_f32 v75, v75
  v_exp_f32 v76, v76
  v_exp_f32 v77, v77
  v_exp_f32 v78, v78
  v_exp_f32 v79, v79
  v_add_f32 v64, 1.0, v64
  v_add_f32 v65, 1.0, v65
  v_add_f32 v66, 1.0, v66
  v_add_f32 v67, 1.0, v67
  v_add_f32 v68, 1.0, v68
  v_add_f32 v69, 1.0, v69
  v_add_f32 v70, 1.0, v70
  v_add_f32 v71, 1.0, v71
  s_setprio 2
  v_add_f32 v72, 1.0, v72
  v_add_f32 v73, 1.0, v73
  v_add_f32 v74, 1.0, v74
  v_add_f32 v75, 1.0, v75
  v_add_f32 v76, 1.0, v76
  v_add_f32 v77, 1.0, v77
  v_add_f32 v78, 1.0, v78
  v_add_f32 v79, 1.0, v79
  v_rcp_f32 v64, v64
  v_rcp_f32 v65, v65
  v_rcp_f32 v66, v66
  v_rcp_f32 v67, v67
  v_rcp_f32 v68, v68
  v_rcp_f32 v69, v69
  v_rcp_f32 v70, v70
  v_rcp_f32 v71, v71
  v_cvt_pk_bf16_f32 v64, v64, v65
  v_cvt_pk_bf16_f32 v65, v66, v67
  v_cvt_pk_bf16_f32 v66, v68, v69
  v_cvt_pk_bf16_f32 v67, v70, v71
  v_rcp_f32 v72, v72
  v_rcp_f32 v73, v73
  ds_read_b32 v21, v15 offset:512
  v_rcp_f32 v74, v74
  v_rcp_f32 v75, v75
  v_rcp_f32 v76, v76
  v_rcp_f32 v77, v77
  v_rcp_f32 v78, v78
  v_rcp_f32 v79, v79
  v_cvt_pk_bf16_f32 v68, v72, v73
  v_cvt_pk_bf16_f32 v69, v74, v75
  v_cvt_pk_bf16_f32 v70, v76, v77
  v_cvt_pk_bf16_f32 v71, v78, v79
LA_vj4:
  s_waitcnt lgkmcnt(0)
  v_readfirstlane_b32 s55, v21
  s_setprio 3
  s_cmp_ge_u32 s55, s93
  s_cbranch_scc0 LA_slow4
LA_b5:
  ds_read_b128 v[96:99], v0 offset:40960
  ds_read_b128 v[100:103], v1 offset:40960
  ds_read_b128 v[104:107], v2 offset:40960
  ds_read_b128 v[108:111], v3 offset:40960
  v_mfma_f32_16x16x32_bf16 v[28:31], v[40:43], v[64:67], v[22:25]
  ds_read_b128 v[112:115], v0 offset:45056
  ds_read_b128 v[116:119], v1 offset:45056
  v_mfma_f32_16x16x32_bf16 v[28:31], v[44:47], v[68:71], v[28:31]
  ds_read_b128 v[120:123], v2 offset:45056
  ds_read_b128 v[124:127], v3 offset:45056
  v_lshl_add_u32 v21, v9, 8, v10
  s_add_u32 m0, s37, 16384
  ds_read_b128 v[88:91], v15 offset:256
  buffer_load_dwordx4 v21, s[4:7], 0 offen nt lds
  s_waitcnt lgkmcnt(8)
  v_mfma_f32_32x32x16_bf16 v[64:79], v[224:227], v[96:99], v[48:63]
  v_mul_f32 v28, v28, v12
  v_mul_f32 v29, v29, v13
  v_cvt_pk_bf16_f32 v28, v28, v29
  ds_write_b32 v14, v28 offset:0
  s_waitcnt lgkmcnt(8)
  v_mfma_f32_32x32x16_bf16 v[64:79], v[228:231], v[100:103], v[64:79]
  s_add_u32 m0, s37, 20352
  ds_read_b64_tr_b16 v[80:81], v4 offset:24576
  buffer_load_dwordx4 v21, s[4:7], 0 offen offset:128 nt lds
  ds_read_b64_tr_b16 v[82:83], v6 offset:24576
  s_waitcnt lgkmcnt(9)
  v_mfma_f32_32x32x16_bf16 v[64:79], v[232:235], v[104:107], v[64:79]
  ds_read_b64_tr_b16 v[84:85], v5 offset:24576
  ds_read_b64_tr_b16 v[86:87], v7 offset:24576
  ds_read_u16 v9, v8 offset:704
  s_waitcnt lgkmcnt(11)
  v_mfma_f32_32x32x16_bf16 v[64:79], v[236:239], v[108:111], v[64:79]
  ds_read_u16_d16_hi v12, v11 offset:384
  ds_read_u16_d16_hi v13, v11 offset:416
  s_add_u32 s92, s92, 4
  s_bitcmp1_b32 s34, 5
  s_cselect_b32 s93, -1, s92
  s_waitcnt lgkmcnt(12)
  v_mfma_f32_32x32x16_bf16 v[64:79], v[240:243], v[112:115], v[64:79]
  s_waitcnt lgkmcnt(11)
  v_mfma_f32_32x32x16_bf16 v[64:79], v[244:247], v[116:119], v[64:79]
  s_waitcnt lgkmcnt(10)
  v_mfma_f32_32x32x16_bf16 v[64:79], v[248:251], v[120:123], v[64:79]
  s_waitcnt lgkmcnt(9)
  v_mfma_f32_32x32x16_bf16 v[64:79], v[252:255], v[124:127], v[64:79]
  s_waitcnt lgkmcnt(5)
  v_mfma_f32_16x16x32_bf16 v[32:35], v[88:91], v[80:83], v[32:35]
  s_waitcnt lgkmcnt(3)
  v_mfma_f32_16x16x32_bf16 v[36:39], v[88:91], v[84:87], v[36:39]
  s_bitcmp1_b32 s40, 6
  s_cbranch_scc1 LA_first5
  s_bitcmp1_b32 s42, 5
  s_waitcnt vmcnt(8)
  s_mov_b64 exec, 1
  ds_inc_u32 v15, v15 offset:512
  s_mov_b64 exec, -1
  s_cbranch_scc1 LA_epi5
LA_done5:
  s_setprio 1
  v_exp_f32 v64, v64
  v_exp_f32 v65, v65
  v_exp_f32 v66, v66
  v_exp_f32 v67, v67
  v_exp_f32 v68, v68
  v_exp_f32 v69, v69
  v_exp_f32 v70, v70
  v_exp_f32 v71, v71
  v_exp_f32 v72, v72
  v_exp_f32 v73, v73
  v_exp_f32 v74, v74
  v_exp_f32 v75, v75
  v_exp_f32 v76, v76
  v_exp_f32 v77, v77
  v_exp_f32 v78, v78
  v_exp_f32 v79, v79
  v_add_f32 v64, 1.0, v64
  v_add_f32 v65, 1.0, v65
  v_add_f32 v66, 1.0, v66
  v_add_f32 v67, 1.0, v67
  v_add_f32 v68, 1.0, v68
  v_add_f32 v69, 1.0, v69
  v_add_f32 v70, 1.0, v70
  v_add_f32 v71, 1.0, v71
  s_setprio 2
  v_add_f32 v72, 1.0, v72
  v_add_f32 v73, 1.0, v73
  v_add_f32 v74, 1.0, v74
  v_add_f32 v75, 1.0, v75
  v_add_f32 v76, 1.0, v76
  v_add_f32 v77, 1.0, v77
  v_add_f32 v78, 1.0, v78
  v_add_f32 v79, 1.0, v79
  v_rcp_f32 v64, v64
  v_rcp_f32 v65, v65
  v_rcp_f32 v66, v66
  v_rcp_f32 v67, v67
  v_rcp_f32 v68, v68
  v_rcp_f32 v69, v69
  v_rcp_f32 v70, v70
  v_rcp_f32 v71, v71
  v_cvt_pk_bf16_f32 v64, v64, v65
  v_cvt_pk_bf16_f32 v65, v66, v67
  v_cvt_pk_bf16_f32 v66, v68, v69
  v_cvt_pk_bf16_f32 v67, v70, v71
  v_rcp_f32 v72, v72
  v_rcp_f32 v73, v73
  ds_read_b32 v21, v15 offset:512
  v_rcp_f32 v74, v74
  v_rcp_f32 v75, v75
  v_rcp_f32 v76, v76
  v_rcp_f32 v77, v77
  v_rcp_f32 v78, v78
  v_rcp_f32 v79, v79
  v_cvt_pk_bf16_f32 v68, v72, v73
  v_cvt_pk_bf16_f32 v69, v74, v75
  v_cvt_pk_bf16_f32 v70, v76, v77
  v_cvt_pk_bf16_f32 v71, v78, v79
LA_vj5:
  s_waitcnt lgkmcnt(0)
  v_readfirstlane_b32 s55, v21
  s_setprio 3
  s_cmp_ge_u32 s55, s93
  s_cbranch_scc0 LA_slow5
LA_b6:
  ds_read_b128 v[96:99], v0 offset:49152
  ds_read_b128 v[100:103], v1 offset:49152
  ds_read_b128 v[104:107], v2 offset:49152
  ds_read_b128 v[108:111], v3 offset:49152
  v_mfma_f32_16x16x32_bf16 v[28:31], v[40:43], v[64:67], v[22:25]
  ds_read_b128 v[112:115], v0 offset:53248
  ds_read_b128 v[116:119], v1 offset:53248
  v_mfma_f32_16x16x32_bf16 v[28:31], v[44:47], v[68:71], v[28:31]
  ds_read_b128 v[120:123], v2 offset:53248
  ds_read_b128 v[124:127], v3 offset:53248
  v_lshl_add_u32 v21, v9, 8, v10
  s_add_u32 m0, s37, 24576
  ds_read_b128 v[88:91], v15 offset:0
  buffer_load_dwordx4 v21, s[4:7], 0 offen nt lds
  s_waitcnt lgkmcnt(8)
  v_mfma_f32_32x32x16_bf16 v[64:79], v[224:227], v[96:99], v[48:63]
  v_mul_f32 v28, v28, v12
  v_mul_f32 v29, v29, v13
  v_cvt_pk_bf16_f32 v28, v28, v29
  ds_write_b32 v14, v28 offset:256
  s_waitcnt lgkmcnt(8)
  v_mfma_f32_32x32x16_bf16 v[64:79], v[228:231], v[100:103], v[64:79]
  s_add_u32 m0, s37, 28544
  ds_read_b64_tr_b16 v[80:81], v4 offset:32768
  buffer_load_dwordx4 v21, s[4:7], 0 offen offset:128 nt lds
  ds_read_b64_tr_b16 v[82:83], v6 offset:32768
  s_waitcnt lgkmcnt(9)
  v_mfma_f32_32x32x16_bf16 v[64:79], v[232:235], v[104:107], v[64:79]
  ds_read_b64_tr_b16 v[84:85], v5 offset:32768
  ds_read_b64_tr_b16 v[86:87], v7 offset:32768
  ds_read_u16 v9, v8 offset:768
  s_waitcnt lgkmcnt(11)
  v_mfma_f32_32x32x16_bf16 v[64:79], v[236:239], v[108:111], v[64:79]
  ds_read_u16_d16_hi v12, v11 offset:448
  ds_read_u16_d16_hi v13, v11 offset:480
  s_add_u32 s92, s92, 4
  s_bitcmp1_b32 s34, 6
  s_cselect_b32 s93, -1, s92
  s_waitcnt lgkmcnt(12)
  v_mfma_f32_32x32x16_bf16 v[64:79], v[240:243], v[112:115], v[64:79]
  s_waitcnt lgkmcnt(11)
  v_mfma_f32_32x32x16_bf16 v[64:79], v[244:247], v[116:119], v[64:79]
  s_waitcnt lgkmcnt(10)
  v_mfma_f32_32x32x16_bf16 v[64:79], v[248:251], v[120:123], v[64:79]
  s_waitcnt lgkmcnt(9)
  v_mfma_f32_32x32x16_bf16 v[64:79], v[252:255], v[124:127], v[64:79]
  s_waitcnt lgkmcnt(5)
  v_mfma_f32_16x16x32_bf16 v[32:35], v[88:91], v[80:83], v[32:35]
  s_waitcnt lgkmcnt(3)
  v_mfma_f32_16x16x32_bf16 v[36:39], v[88:91], v[84:87], v[36:39]
  s_bitcmp1_b32 s40, 7
  s_cbranch_scc1 LA_first6
  s_bitcmp1_b32 s42, 6
  s_waitcnt vmcnt(8)
  s_mov_b64 exec, 1
  ds_inc_u32 v15, v15 offset:512
  s_mov_b64 exec, -1
  s_cbranch_scc1 LA_epi6
LA_done6:
  s_setprio 1
  v_exp_f32 v64, v64
  v_exp_f32 v65, v65
  v_exp_f32 v66, v66
  v_exp_f32 v67, v67
  v_exp_f32 v68, v68
  v_exp_f32 v69, v69
  v_exp_f32 v70, v70
  v_exp_f32 v71, v71
  v_exp_f32 v72, v72
  v_exp_f32 v73, v73
  v_exp_f32 v74, v74
  v_exp_f32 v75, v75
  v_exp_f32 v76, v76
  v_exp_f32 v77, v77
  v_exp_f32 v78, v78
  v_exp_f32 v79, v79
  v_add_f32 v64, 1.0, v64
  v_add_f32 v65, 1.0, v65
  v_add_f32 v66, 1.0, v66
  v_add_f32 v67, 1.0, v67
  v_add_f32 v68, 1.0, v68
  v_add_f32 v69, 1.0, v69
  v_add_f32 v70, 1.0, v70
  v_add_f32 v71, 1.0, v71
  s_setprio 2
  v_add_f32 v72, 1.0, v72
  v_add_f32 v73, 1.0, v73
  v_add_f32 v74, 1.0, v74
  v_add_f32 v75, 1.0, v75
  v_add_f32 v76, 1.0, v76
  v_add_f32 v77, 1.0, v77
  v_add_f32 v78, 1.0, v78
  v_add_f32 v79, 1.0, v79
  v_rcp_f32 v64, v64
  v_rcp_f32 v65, v65
  v_rcp_f32 v66, v66
  v_rcp_f32 v67, v67
  v_rcp_f32 v68, v68
  v_rcp_f32 v69, v69
  v_rcp_f32 v70, v70
  v_rcp_f32 v71, v71
  v_cvt_pk_bf16_f32 v64, v64, v65
  v_cvt_pk_bf16_f32 v65, v66, v67
  v_cvt_pk_bf16_f32 v66, v68, v69
  v_cvt_pk_bf16_f32 v67, v70, v71
  v_rcp_f32 v72, v72
  v_rcp_f32 v73, v73
  ds_read_b32 v21, v15 offset:512
  v_rcp_f32 v74, v74
  v_rcp_f32 v75, v75
  v_rcp_f32 v76, v76
  v_rcp_f32 v77, v77
  v_rcp_f32 v78, v78
  v_rcp_f32 v79, v79
  v_cvt_pk_bf16_f32 v68, v72, v73
  v_cvt_pk_bf16_f32 v69, v74, v75
  v_cvt_pk_bf16_f32 v70, v76, v77
  v_cvt_pk_bf16_f32 v71, v78, v79
LA_vj6:
  s_waitcnt lgkmcnt(0)
  v_readfirstlane_b32 s55, v21
  s_setprio 3
  s_cmp_ge_u32 s55, s93
  s_cbranch_scc0 LA_slow6
LA_b7:
  ds_read_b128 v[96:99], v0 offset:57344
  ds_read_b128 v[100:103], v1 offset:57344
  ds_read_b128 v[104:107], v2 offset:57344
  ds_read_b128 v[108:111], v3 offset:57344
  v_mfma_f32_16x16x32_bf16 v[28:31], v[40:43], v[64:67], v[22:25]
  ds_read_b128 v[112:115], v0 offset:61440
  ds_read_b128 v[116:119], v1 offset:61440
  v_mfma_f32_16x16x32_bf16 v[28:31], v[44:47], v[68:71], v[28:31]
  ds_read_b128 v[120:123], v2 offset:61440
  ds_read_b128 v[124:127], v3 offset:61440
  v_lshl_add_u32 v21, v9, 8, v10
  s_add_u32 m0, s37, 32768
  ds_read_b128 v[88:91], v15 offset:256
  buffer_load_dwordx4 v21, s[4:7], 0 offen nt lds
  s_waitcnt lgkmcnt(8)
  v_mfma_f32_32x32x16_bf16 v[64:79], v[224:227], v[96:99], v[48:63]
  v_mul_f32 v28, v28, v12
  v_mul_f32 v29, v29, v13
  v_cvt_pk_bf16_f32 v28, v28, v29
  ds_write_b32 v14, v28 offset:0
  s_waitcnt lgkmcnt(8)
  v_mfma_f32_32x32x16_bf16 v[64:79], v[228:231], v[100:103], v[64:79]
  s_add_u32 m0, s37, 36736
  ds_read_b64_tr_b16 v[80:81], v4 offset:40960
  buffer_load_dwordx4 v21, s[4:7], 0 offen offset:128 nt lds
  ds_read_b64_tr_b16 v[82:83], v6 offset:40960
  s_waitcnt lgkmcnt(9)
  v_mfma_f32_32x32x16_bf16 v[64:79], v[232:235], v[104:107], v[64:79]
  ds_read_b64_tr_b16 v[84:85], v5 offset:40960
  ds_read_b64_tr_b16 v[86:87], v7 offset:40960
  ds_read_u16 v9, v8 offset:832
  s_waitcnt lgkmcnt(11)
  v_mfma_f32_32x32x16_bf16 v[64:79], v[236:239], v[108:111], v[64:79]
  ds_read_u16_d16_hi v12, v11 offset:512
  ds_read_u16_d16_hi v13, v11 offset:544
  s_add_u32 s92, s92, 4
  s_bitcmp1_b32 s34, 7
  s_cselect_b32 s93, -1, s92
  s_waitcnt lgkmcnt(12)
  v_mfma_f32_32x32x16_bf16 v[64:79], v[240:243], v[112:115], v[64:79]
  s_waitcnt lgkmcnt(11)
  v_mfma_f32_32x32x16_bf16 v[64:79], v[244:247], v[116:119], v[64:79]
  s_waitcnt lgkmcnt(10)
  v_mfma_f32_32x32x16_bf16 v[64:79], v[248:251], v[120:123], v[64:79]
  s_waitcnt lgkmcnt(9)
  v_mfma_f32_32x32x16_bf16 v[64:79], v[252:255], v[124:127], v[64:79]
  s_waitcnt lgkmcnt(5)
  v_mfma_f32_16x16x32_bf16 v[32:35], v[88:91], v[80:83], v[32:35]
  s_waitcnt lgkmcnt(3)
  v_mfma_f32_16x16x32_bf16 v[36:39], v[88:91], v[84:87], v[36:39]
  s_bitcmp1_b32 s40, 8
  s_cbranch_scc1 LA_first7
  s_bitcmp1_b32 s42, 7
  s_waitcnt vmcnt(8)
  s_mov_b64 exec, 1
  ds_inc_u32 v15, v15 offset:512
  s_mov_b64 exec, -1
  s_cbranch_scc1 LA_epi7
LA_done7:
  s_setprio 1
  v_exp_f32 v64, v64
  v_exp_f32 v65, v65
  v_exp_f32 v66, v66
  v_exp_f32 v67, v67
  v_exp_f32 v68, v68
  v_exp_f32 v69, v69
  v_exp_f32 v70, v70
  v_exp_f32 v71, v71
  v_exp_f32 v72, v72
  v_exp_f32 v73, v73
  v_exp_f32 v74, v74
  v_exp_f32 v75, v75
  v_exp_f32 v76, v76
  v_exp_f32 v77, v77
  v_exp_f32 v78, v78
  v_exp_f32 v79, v79
  v_add_f32 v64, 1.0, v64
  v_add_f32 v65, 1.0, v65
  v_add_f32 v66, 1.0, v66
  v_add_f32 v67, 1.0, v67
  v_add_f32 v68, 1.0, v68
  v_add_f32 v69, 1.0, v69
  v_add_f32 v70, 1.0, v70
  v_add_f32 v71, 1.0, v71
  s_setprio 2
  v_add_f32 v72, 1.0, v72
  v_add_f32 v73, 1.0, v73
  v_add_f32 v74, 1.0, v74
  v_add_f32 v75, 1.0, v75
  v_add_f32 v76, 1.0, v76
  v_add_f32 v77, 1.0, v77
  v_add_f32 v78, 1.0, v78
  v_add_f32 v79, 1.0, v79
  v_rcp_f32 v64, v64
  v_rcp_f32 v65, v65
  v_rcp_f32 v66, v66
  v_rcp_f32 v67, v67
  v_rcp_f32 v68, v68
  v_rcp_f32 v69, v69
  v_rcp_f32 v70, v70
  v_rcp_f32 v71, v71
  v_cvt_pk_bf16_f32 v64, v64, v65
  v_cvt_pk_bf16_f32 v65, v66, v67
  v_cvt_pk_bf16_f32 v66, v68, v69
  v_cvt_pk_bf16_f32 v67, v70, v71
  v_rcp_f32 v72, v72
  v_rcp_f32 v73, v73
  ds_read_b32 v21, v15 offset:512
  v_rcp_f32 v74, v74
  v_rcp_f32 v75, v75
  v_rcp_f32 v76, v76
  v_rcp_f32 v77, v77
  v_rcp_f32 v78, v78
  v_rcp_f32 v79, v79
  v_cvt_pk_bf16_f32 v68, v72, v73
  v_cvt_pk_bf16_f32 v69, v74, v75
  v_cvt_pk_bf16_f32 v70, v76, v77
  v_cvt_pk_bf16_f32 v71, v78, v79
LA_vj7:
  v_add_u32 v8, 512, v8
  v_add_u32 v11, 512, v11
  s_lshr_b64 s[40:41], s[40:41], 8
  s_lshr_b64 s[42:43], s[42:43], 8
  s_lshr_b64 s[34:35], s[34:35], 8
  s_waitcnt lgkmcnt(0)
  v_readfirstlane_b32 s55, v21
  s_setprio 3
  s_cmp_ge_u32 s55, s93
  s_cbranch_scc0 LA_slow7
  s_branch LA_b0
LA_first0:
  ds_read_b128 v[80:83], v16 offset:0
  ds_read_b128 v[84:87], v17 offset:0
  ds_read_b128 v[88:91], v16 offset:528
  ds_read_b128 v[92:95], v17 offset:528
  ds_write_b16 v18, v24
  s_bitcmp1_b32 s42, 0
  s_waitcnt vmcnt(8)
  s_mov_b64 exec, 1
  ds_inc_u32 v15, v15 offset:512
  s_mov_b64 exec, -1
  ds_read_b128 v[48:51], v16 offset:1056
  ds_read_b128 v[52:55], v17 offset:1056
  ds_read_b128 v[56:59], v16 offset:1584
  ds_read_b128 v[60:63], v17 offset:1584
  s_cbranch_scc1 LA_fepi0
LA_fdone0:
  s_setprio 1
  v_exp_f32 v64, v64
  v_exp_f32 v65, v65
  s_waitcnt lgkmcnt(4)
  v_mfma_f32_32x32x16_bf16 v[96:111], v[80:83], v[192:195], v[128:143]
  v_exp_f32 v66, v66
  v_exp_f32 v67, v67
  v_exp_f32 v68, v68
  v_mfma_f32_32x32x16_bf16 v[96:111], v[84:87], v[196:199], v[96:111]
  v_exp_f32 v69, v69
  v_exp_f32 v70, v70
  v_exp_f32 v71, v71
  v_mfma_f32_32x32x16_bf16 v[112:127], v[88:91], v[200:203], v[144:159]
  v_exp_f32 v72, v72
  v_exp_f32 v73, v73
  v_exp_f32 v74, v74
  v_mfma_f32_32x32x16_bf16 v[112:127], v[92:95], v[204:207], v[112:127]
  v_exp_f32 v75, v75
  v_exp_f32 v76, v76
  v_exp_f32 v77, v77
  v_exp_f32 v78, v78
  v_exp_f32 v79, v79
  v_add_f32 v64, 1.0, v64
  v_add_f32 v65, 1.0, v65
  v_add_f32 v66, 1.0, v66
  s_setprio 2
  v_add_f32 v67, 1.0, v67
  v_add_f32 v68, 1.0, v68
  v_add_f32 v69, 1.0, v69
  v_add_f32 v70, 1.0, v70
  v_add_f32 v71, 1.0, v71
  v_add_f32 v72, 1.0, v72
  v_add_f32 v73, 1.0, v73
  v_add_f32 v74, 1.0, v74
  v_add_f32 v75, 1.0, v75
  v_add_f32 v76, 1.0, v76
  v_add_f32 v77, 1.0, v77
  v_add_f32 v78, 1.0, v78
  v_add_f32 v79, 1.0, v79
  v_cvt_pk_bf16_f32 v224, v96, v97
  v_cvt_pk_bf16_f32 v225, v98, v99
  v_cvt_pk_bf16_f32 v226, v100, v101
  v_cvt_pk_bf16_f32 v227, v102, v103
  v_cvt_pk_bf16_f32 v228, v104, v105
  v_cvt_pk_bf16_f32 v229, v106, v107
  v_cvt_pk_bf16_f32 v230, v108, v109
  v_cvt_pk_bf16_f32 v231, v110, v111
  v_cvt_pk_bf16_f32 v232, v112, v113
  v_cvt_pk_bf16_f32 v233, v114, v115
  v_cvt_pk_bf16_f32 v234, v116, v117
  v_cvt_pk_bf16_f32 v235, v118, v119
  v_cvt_pk_bf16_f32 v236, v120, v121
  v_cvt_pk_bf16_f32 v237, v122, v123
  v_cvt_pk_bf16_f32 v238, v124, v125
  v_cvt_pk_bf16_f32 v239, v126, v127
  v_rcp_f32 v64, v64
  v_rcp_f32 v65, v65
  v_rcp_f32 v66, v66
  v_rcp_f32 v67, v67
  v_rcp_f32 v68, v68
  v_rcp_f32 v69, v69
  v_rcp_f32 v70, v70
  v_rcp_f32 v71, v71
  v_cvt_pk_bf16_f32 v64, v64, v65
  v_cvt_pk_bf16_f32 v65, v66, v67
  v_cvt_pk_bf16_f32 v66, v68, v69
  v_cvt_pk_bf16_f32 v67, v70, v71
  s_waitcnt lgkmcnt(0)
  v_mfma_f32_32x32x16_bf16 v[96:111], v[48:51], v[208:211], v[160:175]
  v_rcp_f32 v72, v72
  v_rcp_f32 v73, v73
  v_rcp_f32 v74, v74
  v_mfma_f32_32x32x16_bf16 v[96:111], v[52:55], v[212:215], v[96:111]
  v_rcp_f32 v75, v75
  v_rcp_f32 v76, v76
  v_rcp_f32 v77, v77
  v_mfma_f32_32x32x16_bf16 v[112:127], v[56:59], v[216:219], v[176:191]
  v_rcp_f32 v78, v78
  v_rcp_f32 v79, v79
  v_mfma_f32_32x32x16_bf16 v[112:127], v[60:63], v[220:223], v[112:127]
  ds_read_b128 v[48:51], v19 offset:0
  ds_read_b128 v[52:55], v19 offset:32
  ds_read_b128 v[56:59], v19 offset:64
  ds_read_b128 v[60:63], v19 offset:96
  v_cvt_pk_bf16_f32 v68, v72, v73
  v_cvt_pk_bf16_f32 v69, v74, v75
  v_cvt_pk_bf16_f32 v70, v76, v77
  v_cvt_pk_bf16_f32 v71, v78, v79
  v_alignbit_b32 v24, v25, v24, 16
  v_alignbit_b32 v25, v26, v25, 16
  v_alignbit_b32 v26, v27, v26, 16
  v_lshrrev_b32 v27, 16, v27
  v_add_u32 v19, 0x200, v19
  v_add_u32 v16, s44, v16
  v_add_u32 v17, s44, v17
  s_sub_u32 s44, 0, s44
  v_add_u32 v18, s44, v18
  v_cvt_pk_bf16_f32 v240, v96, v97
  v_cvt_pk_bf16_f32 v241, v98, v99
  v_cvt_pk_bf16_f32 v242, v100, v101
  v_cvt_pk_bf16_f32 v243, v102, v103
  v_cvt_pk_bf16_f32 v244, v104, v105
  v_cvt_pk_bf16_f32 v245, v106, v107
  ds_read_b32 v21, v15 offset:512
  v_cvt_pk_bf16_f32 v246, v108, v109
  v_cvt_pk_bf16_f32 v247, v110, v111
  v_cvt_pk_bf16_f32 v248, v112, v113
  v_cvt_pk_bf16_f32 v249, v114, v115
  v_cvt_pk_bf16_f32 v250, v116, v117
  v_cvt_pk_bf16_f32 v251, v118, v119
  v_cvt_pk_bf16_f32 v252, v120, v121
  v_cvt_pk_bf16_f32 v253, v122, v123
  v_cvt_pk_bf16_f32 v254, v124, v125
  v_cvt_pk_bf16_f32 v255, v126, v127
  s_branch LA_vj0
LA_first1:
  ds_read_b128 v[80:83], v16 offset:0
  ds_read_b128 v[84:87], v17 offset:0
  ds_read_b128 v[88:91], v16 offset:528
  ds_read_b128 v[92:95], v17 offset:528
  ds_write_b16 v18, v24
  s_bitcmp1_b32 s42, 1
  s_waitcnt vmcnt(8)
  s_mov_b64 exec, 1
  ds_inc_u32 v15, v15 offset:512
  s_mov_b64 exec, -1
  ds_read_b128 v[48:51], v16 offset:1056
  ds_read_b128 v[52:55], v17 offset:1056
  ds_read_b128 v[56:59], v16 offset:1584
  ds_read_b128 v[60:63], v17 offset:1584
  s_cbranch_scc1 LA_fepi1
LA_fdone1:
  s_setprio 1
  v_exp_f32 v64, v64
  v_exp_f32 v65, v65
  s_waitcnt lgkmcnt(4)
  v_mfma_f32_32x32x16_bf16 v[96:111], v[80:83], v[192:195], v[128:143]
  v_exp_f32 v66, v66
  v_exp_f32 v67, v67
  v_exp_f32 v68, v68
  v_mfma_f32_32x32x16_bf16 v[96:111], v[84:87], v[196:199], v[96:111]
  v_exp_f32 v69, v69
  v_exp_f32 v70, v70
  v_exp_f32 v71, v71
  v_mfma_f32_32x32x16_bf16 v[112:127], v[88:91], v[200:203], v[144:159]
  v_exp_f32 v72, v72
  v_exp_f32 v73, v73
  v_exp_f32 v74, v74
  v_mfma_f32_32x32x16_bf16 v[112:127], v[92:95], v[204:207], v[112:127]
  v_exp_f32 v75, v75
  v_exp_f32 v76, v76
  v_exp_f32 v77, v77
  v_exp_f32 v78, v78
  v_exp_f32 v79, v79
  v_add_f32 v64, 1.0, v64
  v_add_f32 v65, 1.0, v65
  v_add_f32 v66, 1.0, v66
  s_setprio 2
  v_add_f32 v67, 1.0, v67
  v_add_f32 v68, 1.0, v68
  v_add_f32 v69, 1.0, v69
  v_add_f32 v70, 1.0, v70
  v_add_f32 v71, 1.0, v71
  v_add_f32 v72, 1.0, v72
  v_add_f32 v73, 1.0, v73
  v_add_f32 v74, 1.0, v74
  v_add_f32 v75, 1.0, v75
  v_add_f32 v76, 1.0, v76
  v_add_f32 v77, 1.0, v77
  v_add_f32 v78, 1.0, v78
  v_add_f32 v79, 1.0, v79
  v_cvt_pk_bf16_f32 v224, v96, v97
  v_cvt_pk_bf16_f32 v225, v98, v99
  v_cvt_pk_bf16_f32 v226, v100, v101
  v_cvt_pk_bf16_f32 v227, v102, v103
  v_cvt_pk_bf16_f32 v228, v104, v105
  v_cvt_pk_bf16_f32 v229, v106, v107
  v_cvt_pk_bf16_f32 v230, v108, v109
  v_cvt_pk_bf16_f32 v231, v110, v111
  v_cvt_pk_bf16_f32 v232, v112, v113
  v_cvt_pk_bf16_f32 v233, v114, v115
  v_cvt_pk_bf16_f32 v234, v116, v117
  v_cvt_pk_bf16_f32 v235, v118, v119
  v_cvt_pk_bf16_f32 v236, v120, v121
  v_cvt_pk_bf16_f32 v237, v122, v123
  v_cvt_pk_bf16_f32 v238, v124, v125
  v_cvt_pk_bf16_f32 v239, v126, v127
  v_rcp_f32 v64, v64
  v_rcp_f32 v65, v65
  v_rcp_f32 v66, v66
  v_rcp_f32 v67, v67
  v_rcp_f32 v68, v68
  v_rcp_f32 v69, v69
  v_rcp_f32 v70, v70
  v_rcp_f32 v71, v71
  v_cvt_pk_bf16_f32 v64, v64, v65
  v_cvt_pk_bf16_f32 v65, v66, v67
  v_cvt_pk_bf16_f32 v66, v68, v69
  v_cvt_pk_bf16_f32 v67, v70, v71
  s_waitcnt lgkmcnt(0)
  v_mfma_f32_32x32x16_bf16 v[96:111], v[48:51], v[208:211], v[160:175]
  v_rcp_f32 v72, v72
  v_rcp_f32 v73, v73
  v_rcp_f32 v74, v74
  v_mfma_f32_32x32x16_bf16 v[96:111], v[52:55], v[212:215], v[96:111]
  v_rcp_f32 v75, v75
  v_rcp_f32 v76, v76
  v_rcp_f32 v77, v77
  v_mfma_f32_32x32x16_bf16 v[112:127], v[56:59], v[216:219], v[176:191]
  v_rcp_f32 v78, v78
  v_rcp_f32 v79, v79
  v_mfma_f32_32x32x16_bf16 v[112:127], v[60:63], v[220:223], v[112:127]
  ds_read_b128 v[48:51], v19 offset:0
  ds_read_b128 v[52:55], v19 offset:32
  ds_read_b128 v[56:59], v19 offset:64
  ds_read_b128 v[60:63], v19 offset:96
  v_cvt_pk_bf16_f32 v68, v72, v73
  v_cvt_pk_bf16_f32 v69, v74, v75
  v_cvt_pk_bf16_f32 v70, v76, v77
  v_cvt_pk_bf16_f32 v71, v78, v79
  v_alignbit_b32 v24, v25, v24, 16
  v_alignbit_b32 v25, v26, v25, 16
  v_alignbit_b32 v26, v27, v26, 16
  v_lshrrev_b32 v27, 16, v27
  v_add_u32 v19, 0x200, v19
  v_add_u32 v16, s44, v16
  v_add_u32 v17, s44, v17
  s_sub_u32 s44, 0, s44
  v_add_u32 v18, s44, v18
  v_cvt_pk_bf16_f32 v240, v96, v97
  v_cvt_pk_bf16_f32 v241, v98, v99
  v_cvt_pk_bf16_f32 v242, v100, v101
  v_cvt_pk_bf16_f32 v243, v102, v103
  v_cvt_pk_bf16_f32 v244, v104, v105
  v_cvt_pk_bf16_f32 v245, v106, v107
  ds_read_b32 v21, v15 offset:512
  v_cvt_pk_bf16_f32 v246, v108, v109
  v_cvt_pk_bf16_f32 v247, v110, v111
  v_cvt_pk_bf16_f32 v248, v112, v113
  v_cvt_pk_bf16_f32 v249, v114, v115
  v_cvt_pk_bf16_f32 v250, v116, v117
  v_cvt_pk_bf16_f32 v251, v118, v119
  v_cvt_pk_bf16_f32 v252, v120, v121
  v_cvt_pk_bf16_f32 v253, v122, v123
  v_cvt_pk_bf16_f32 v254, v124, v125
  v_cvt_pk_bf16_f32 v255, v126, v127
  s_branch LA_vj1
LA_first2:
  ds_read_b128 v[80:83], v16 offset:0
  ds_read_b128 v[84:87], v17 offset:0
  ds_read_b128 v[88:91], v16 offset:528
  ds_read_b128 v[92:95], v17 offset:528
  ds_write_b16 v18, v24
  s_bitcmp1_b32 s42, 2
  s_waitcnt vmcnt(8)
  s_mov_b64 exec, 1
  ds_inc_u32 v15, v15 offset:512
  s_mov_b64 exec, -1
  ds_read_b128 v[48:51], v16 offset:1056
  ds_read_b128 v[52:55], v17 offset:1056
  ds_read_b128 v[56:59], v16 offset:1584
  ds_read_b128 v[60:63], v17 offset:1584
  s_cbranch_scc1 LA_fepi2
LA_fdone2:
  s_setprio 1
  v_exp_f32 v64, v64
  v_exp_f32 v65, v65
  s_waitcnt lgkmcnt(4)
  v_mfma_f32_32x32x16_bf16 v[96:111], v[80:83], v[192:195], v[128:143]
  v_exp_f32 v66, v66
  v_exp_f32 v67, v67
  v_exp_f32 v68, v68
  v_mfma_f32_32x32x16_bf16 v[96:111], v[84:87], v[196:199], v[96:111]
  v_exp_f32 v69, v69
  v_exp_f32 v70, v70
  v_exp_f32 v71, v71
  v_mfma_f32_32x32x16_bf16 v[112:127], v[88:91], v[200:203], v[144:159]
  v_exp_f32 v72, v72
  v_exp_f32 v73, v73
  v_exp_f32 v74, v74
  v_mfma_f32_32x32x16_bf16 v[112:127], v[92:95], v[204:207], v[112:127]
  v_exp_f32 v75, v75
  v_exp_f32 v76, v76
  v_exp_f32 v77, v77
  v_exp_f32 v78, v78
  v_exp_f32 v79, v79
  v_add_f32 v64, 1.0, v64
  v_add_f32 v65, 1.0, v65
  v_add_f32 v66, 1.0, v66
  s_setprio 2
  v_add_f32 v67, 1.0, v67
  v_add_f32 v68, 1.0, v68
  v_add_f32 v69, 1.0, v69
  v_add_f32 v70, 1.0, v70
  v_add_f32 v71, 1.0, v71
  v_add_f32 v72, 1.0, v72
  v_add_f32 v73, 1.0, v73
  v_add_f32 v74, 1.0, v74
  v_add_f32 v75, 1.0, v75
  v_add_f32 v76, 1.0, v76
  v_add_f32 v77, 1.0, v77
  v_add_f32 v78, 1.0, v78
  v_add_f32 v79, 1.0, v79
  v_cvt_pk_bf16_f32 v224, v96, v97
  v_cvt_pk_bf16_f32 v225, v98, v99
  v_cvt_pk_bf16_f32 v226, v100, v101
  v_cvt_pk_bf16_f32 v227, v102, v103
  v_cvt_pk_bf16_f32 v228, v104, v105
  v_cvt_pk_bf16_f32 v229, v106, v107
  v_cvt_pk_bf16_f32 v230, v108, v109
  v_cvt_pk_bf16_f32 v231, v110, v111
  v_cvt_pk_bf16_f32 v232, v112, v113
  v_cvt_pk_bf16_f32 v233, v114, v115
  v_cvt_pk_bf16_f32 v234, v116, v117
  v_cvt_pk_bf16_f32 v235, v118, v119
  v_cvt_pk_bf16_f32 v236, v120, v121
  v_cvt_pk_bf16_f32 v237, v122, v123
  v_cvt_pk_bf16_f32 v238, v124, v125
  v_cvt_pk_bf16_f32 v239, v126, v127
  v_rcp_f32 v64, v64
  v_rcp_f32 v65, v65
  v_rcp_f32 v66, v66
  v_rcp_f32 v67, v67
  v_rcp_f32 v68, v68
  v_rcp_f32 v69, v69
  v_rcp_f32 v70, v70
  v_rcp_f32 v71, v71
  v_cvt_pk_bf16_f32 v64, v64, v65
  v_cvt_pk_bf16_f32 v65, v66, v67
  v_cvt_pk_bf16_f32 v66, v68, v69
  v_cvt_pk_bf16_f32 v67, v70, v71
  s_waitcnt lgkmcnt(0)
  v_mfma_f32_32x32x16_bf16 v[96:111], v[48:51], v[208:211], v[160:175]
  v_rcp_f32 v72, v72
  v_rcp_f32 v73, v73
  v_rcp_f32 v74, v74
  v_mfma_f32_32x32x16_bf16 v[96:111], v[52:55], v[212:215], v[96:111]
  v_rcp_f32 v75, v75
  v_rcp_f32 v76, v76
  v_rcp_f32 v77, v77
  v_mfma_f32_32x32x16_bf16 v[112:127], v[56:59], v[216:219], v[176:191]
  v_rcp_f32 v78, v78
  v_rcp_f32 v79, v79
  v_mfma_f32_32x32x16_bf16 v[112:127], v[60:63], v[220:223], v[112:127]
  ds_read_b128 v[48:51], v19 offset:0
  ds_read_b128 v[52:55], v19 offset:32
  ds_read_b128 v[56:59], v19 offset:64
  ds_read_b128 v[60:63], v19 offset:96
  v_cvt_pk_bf16_f32 v68, v72, v73
  v_cvt_pk_bf16_f32 v69, v74, v75
  v_cvt_pk_bf16_f32 v70, v76, v77
  v_cvt_pk_bf16_f32 v71, v78, v79
  v_alignbit_b32 v24, v25, v24, 16
  v_alignbit_b32 v25, v26, v25, 16
  v_alignbit_b32 v26, v27, v26, 16
  v_lshrrev_b32 v27, 16, v27
  v_add_u32 v19, 0x200, v19
  v_add_u32 v16, s44, v16
  v_add_u32 v17, s44, v17
  s_sub_u32 s44, 0, s44
  v_add_u32 v18, s44, v18
  v_cvt_pk_bf16_f32 v240, v96, v97
  v_cvt_pk_bf16_f32 v241, v98, v99
  v_cvt_pk_bf16_f32 v242, v100, v101
  v_cvt_pk_bf16_f32 v243, v102, v103
  v_cvt_pk_bf16_f32 v244, v104, v105
  v_cvt_pk_bf16_f32 v245, v106, v107
  ds_read_b32 v21, v15 offset:512
  v_cvt_pk_bf16_f32 v246, v108, v109
  v_cvt_pk_bf16_f32 v247, v110, v111
  v_cvt_pk_bf16_f32 v248, v112, v113
  v_cvt_pk_bf16_f32 v249, v114, v115
  v_cvt_pk_bf16_f32 v250, v116, v117
  v_cvt_pk_bf16_f32 v251, v118, v119
  v_cvt_pk_bf16_f32 v252, v120, v121
  v_cvt_pk_bf16_f32 v253, v122, v123
  v_cvt_pk_bf16_f32 v254, v124, v125
  v_cvt_pk_bf16_f32 v255, v126, v127
  s_branch LA_vj2
LA_first3:
  ds_read_b128 v[80:83], v16 offset:0
  ds_read_b128 v[84:87], v17 offset:0
  ds_read_b128 v[88:91], v16 offset:528
  ds_read_b128 v[92:95], v17 offset:528
  ds_write_b16 v18, v24
  s_bitcmp1_b32 s42, 3
  s_waitcnt vmcnt(8)
  s_mov_b64 exec, 1
  ds_inc_u32 v15, v15 offset:512
  s_mov_b64 exec, -1
  ds_read_b128 v[48:51], v16 offset:1056
  ds_read_b128 v[52:55], v17 offset:1056
  ds_read_b128 v[56:59], v16 offset:1584
  ds_read_b128 v[60:63], v17 offset:1584
  s_cbranch_scc1 LA_fepi3
LA_fdone3:
  s_setprio 1
  v_exp_f32 v64, v64
  v_exp_f32 v65, v65
  s_waitcnt lgkmcnt(4)
  v_mfma_f32_32x32x16_bf16 v[96:111], v[80:83], v[192:195], v[128:143]
  v_exp_f32 v66, v66
  v_exp_f32 v67, v67
  v_exp_f32 v68, v68
  v_mfma_f32_32x32x16_bf16 v[96:111], v[84:87], v[196:199], v[96:111]
  v_exp_f32 v69, v69
  v_exp_f32 v70, v70
  v_exp_f32 v71, v71
  v_mfma_f32_32x32x16_bf16 v[112:127], v[88:91], v[200:203], v[144:159]
  v_exp_f32 v72, v72
  v_exp_f32 v73, v73
  v_exp_f32 v74, v74
  v_mfma_f32_32x32x16_bf16 v[112:127], v[92:95], v[204:207], v[112:127]
  v_exp_f32 v75, v75
  v_exp_f32 v76, v76
  v_exp_f32 v77, v77
  v_exp_f32 v78, v78
  v_exp_f32 v79, v79
  v_add_f32 v64, 1.0, v64
  v_add_f32 v65, 1.0, v65
  v_add_f32 v66, 1.0, v66
  s_setprio 2
  v_add_f32 v67, 1.0, v67
  v_add_f32 v68, 1.0, v68
  v_add_f32 v69, 1.0, v69
  v_add_f32 v70, 1.0, v70
  v_add_f32 v71, 1.0, v71
  v_add_f32 v72, 1.0, v72
  v_add_f32 v73, 1.0, v73
  v_add_f32 v74, 1.0, v74
  v_add_f32 v75, 1.0, v75
  v_add_f32 v76, 1.0, v76
  v_add_f32 v77, 1.0, v77
  v_add_f32 v78, 1.0, v78
  v_add_f32 v79, 1.0, v79
  v_cvt_pk_bf16_f32 v224, v96, v97
  v_cvt_pk_bf16_f32 v225, v98, v99
  v_cvt_pk_bf16_f32 v226, v100, v101
  v_cvt_pk_bf16_f32 v227, v102, v103
  v_cvt_pk_bf16_f32 v228, v104, v105
  v_cvt_pk_bf16_f32 v229, v106, v107
  v_cvt_pk_bf16_f32 v230, v108, v109
  v_cvt_pk_bf16_f32 v231, v110, v111
  v_cvt_pk_bf16_f32 v232, v112, v113
  v_cvt_pk_bf16_f32 v233, v114, v115
  v_cvt_pk_bf16_f32 v234, v116, v117
  v_cvt_pk_bf16_f32 v235, v118, v119
  v_cvt_pk_bf16_f32 v236, v120, v121
  v_cvt_pk_bf16_f32 v237, v122, v123
  v_cvt_pk_bf16_f32 v238, v124, v125
  v_cvt_pk_bf16_f32 v239, v126, v127
  v_rcp_f32 v64, v64
  v_rcp_f32 v65, v65
  v_rcp_f32 v66, v66
  v_rcp_f32 v67, v67
  v_rcp_f32 v68, v68
  v_rcp_f32 v69, v69
  v_rcp_f32 v70, v70
  v_rcp_f32 v71, v71
  v_cvt_pk_bf16_f32 v64, v64, v65
  v_cvt_pk_bf16_f32 v65, v66, v67
  v_cvt_pk_bf16_f32 v66, v68, v69
  v_cvt_pk_bf16_f32 v67, v70, v71
  s_waitcnt lgkmcnt(0)
  v_mfma_f32_32x32x16_bf16 v[96:111], v[48:51], v[208:211], v[160:175]
  v_rcp_f32 v72, v72
  v_rcp_f32 v73, v73
  v_rcp_f32 v74, v74
  v_mfma_f32_32x32x16_bf16 v[96:111], v[52:55], v[212:215], v[96:111]
  v_rcp_f32 v75, v75
  v_rcp_f32 v76, v76
  v_rcp_f32 v77, v77
  v_mfma_f32_32x32x16_bf16 v[112:127], v[56:59], v[216:219], v[176:191]
  v_rcp_f32 v78, v78
  v_rcp_f32 v79, v79
  v_mfma_f32_32x32x16_bf16 v[112:127], v[60:63], v[220:223], v[112:127]
  ds_read_b128 v[48:51], v19 offset:0
  ds_read_b128 v[52:55], v19 offset:32
  ds_read_b128 v[56:59], v19 offset:64
  ds_read_b128 v[60:63], v19 offset:96
  v_cvt_pk_bf16_f32 v68, v72, v73
  v_cvt_pk_bf16_f32 v69, v74, v75
  v_cvt_pk_bf16_f32 v70, v76, v77
  v_cvt_pk_bf16_f32 v71, v78, v79
  v_alignbit_b32 v24, v25, v24, 16
  v_alignbit_b32 v25, v26, v25, 16
  v_alignbit_b32 v26, v27, v26, 16
  v_lshrrev_b32 v27, 16, v27
  v_add_u32 v19, 0x200, v19
  v_add_u32 v16, s44, v16
  v_add_u32 v17, s44, v17
  s_sub_u32 s44, 0, s44
  v_add_u32 v18, s44, v18
  v_cvt_pk_bf16_f32 v240, v96, v97
  v_cvt_pk_bf16_f32 v241, v98, v99
  v_cvt_pk_bf16_f32 v242, v100, v101
  v_cvt_pk_bf16_f32 v243, v102, v103
  v_cvt_pk_bf16_f32 v244, v104, v105
  v_cvt_pk_bf16_f32 v245, v106, v107
  ds_read_b32 v21, v15 offset:512
  v_cvt_pk_bf16_f32 v246, v108, v109
  v_cvt_pk_bf16_f32 v247, v110, v111
  v_cvt_pk_bf16_f32 v248, v112, v113
  v_cvt_pk_bf16_f32 v249, v114, v115
  v_cvt_pk_bf16_f32 v250, v116, v117
  v_cvt_pk_bf16_f32 v251, v118, v119
  v_cvt_pk_bf16_f32 v252, v120, v121
  v_cvt_pk_bf16_f32 v253, v122, v123
  v_cvt_pk_bf16_f32 v254, v124, v125
  v_cvt_pk_bf16_f32 v255, v126, v127
  s_branch LA_vj3
LA_first4:
  ds_read_b128 v[80:83], v16 offset:0
  ds_read_b128 v[84:87], v17 offset:0
  ds_read_b128 v[88:91], v16 offset:528
  ds_read_b128 v[92:95], v17 offset:528
  ds_write_b16 v18, v24
  s_bitcmp1_b32 s42, 4
  s_waitcnt vmcnt(8)
  s_mov_b64 exec, 1
  ds_inc_u32 v15, v15 offset:512
  s_mov_b64 exec, -1
  ds_read_b128 v[48:51], v16 offset:1056
  ds_read_b128 v[52:55], v17 offset:1056
  ds_read_b128 v[56:59], v16 offset:1584
  ds_read_b128 v[60:63], v17 offset:1584
  s_cbranch_scc1 LA_fepi4
LA_fdone4:
  s_setprio 1
  v_exp_f32 v64, v64
  v_exp_f32 v65, v65
  s_waitcnt lgkmcnt(4)
  v_mfma_f32_32x32x16_bf16 v[96:111], v[80:83], v[192:195], v[128:143]
  v_exp_f32 v66, v66
  v_exp_f32 v67, v67
  v_exp_f32 v68, v68
  v_mfma_f32_32x32x16_bf16 v[96:111], v[84:87], v[196:199], v[96:111]
  v_exp_f32 v69, v69
  v_exp_f32 v70, v70
  v_exp_f32 v71, v71
  v_mfma_f32_32x32x16_bf16 v[112:127], v[88:91], v[200:203], v[144:159]
  v_exp_f32 v72, v72
  v_exp_f32 v73, v73
  v_exp_f32 v74, v74
  v_mfma_f32_32x32x16_bf16 v[112:127], v[92:95], v[204:207], v[112:127]
  v_exp_f32 v75, v75
  v_exp_f32 v76, v76
  v_exp_f32 v77, v77
  v_exp_f32 v78, v78
  v_exp_f32 v79, v79
  v_add_f32 v64, 1.0, v64
  v_add_f32 v65, 1.0, v65
  v_add_f32 v66, 1.0, v66
  s_setprio 2
  v_add_f32 v67, 1.0, v67
  v_add_f32 v68, 1.0, v68
  v_add_f32 v69, 1.0, v69
  v_add_f32 v70, 1.0, v70
  v_add_f32 v71, 1.0, v71
  v_add_f32 v72, 1.0, v72
  v_add_f32 v73, 1.0, v73
  v_add_f32 v74, 1.0, v74
  v_add_f32 v75, 1.0, v75
  v_add_f32 v76, 1.0, v76
  v_add_f32 v77, 1.0, v77
  v_add_f32 v78, 1.0, v78
  v_add_f32 v79, 1.0, v79
  v_cvt_pk_bf16_f32 v224, v96, v97
  v_cvt_pk_bf16_f32 v225, v98, v99
  v_cvt_pk_bf16_f32 v226, v100, v101
  v_cvt_pk_bf16_f32 v227, v102, v103
  v_cvt_pk_bf16_f32 v228, v104, v105
  v_cvt_pk_bf16_f32 v229, v106, v107
  v_cvt_pk_bf16_f32 v230, v108, v109
  v_cvt_pk_bf16_f32 v231, v110, v111
  v_cvt_pk_bf16_f32 v232, v112, v113
  v_cvt_pk_bf16_f32 v233, v114, v115
  v_cvt_pk_bf16_f32 v234, v116, v117
  v_cvt_pk_bf16_f32 v235, v118, v119
  v_cvt_pk_bf16_f32 v236, v120, v121
  v_cvt_pk_bf16_f32 v237, v122, v123
  v_cvt_pk_bf16_f32 v238, v124, v125
  v_cvt_pk_bf16_f32 v239, v126, v127
  v_rcp_f32 v64, v64
  v_rcp_f32 v65, v65
  v_rcp_f32 v66, v66
  v_rcp_f32 v67, v67
  v_rcp_f32 v68, v68
  v_rcp_f32 v69, v69
  v_rcp_f32 v70, v70
  v_rcp_f32 v71, v71
  v_cvt_pk_bf16_f32 v64, v64, v65
  v_cvt_pk_bf16_f32 v65, v66, v67
  v_cvt_pk_bf16_f32 v66, v68, v69
  v_cvt_pk_bf16_f32 v67, v70, v71
  s_waitcnt lgkmcnt(0)
  v_mfma_f32_32x32x16_bf16 v[96:111], v[48:51], v[208:211], v[160:175]
  v_rcp_f32 v72, v72
  v_rcp_f32 v73, v73
  v_rcp_f32 v74, v74
  v_mfma_f32_32x32x16_bf16 v[96:111], v[52:55], v[212:215], v[96:111]
  v_rcp_f32 v75, v75
  v_rcp_f32 v76, v76
  v_rcp_f32 v77, v77
  v_mfma_f32_32x32x16_bf16 v[112:127], v[56:59], v[216:219], v[176:191]
  v_rcp_f32 v78, v78
  v_rcp_f32 v79, v79
  v_mfma_f32_32x32x16_bf16 v[112:127], v[60:63], v[220:223], v[112:127]
  ds_read_b128 v[48:51], v19 offset:0
  ds_read_b128 v[52:55], v19 offset:32
  ds_read_b128 v[56:59], v19 offset:64
  ds_read_b128 v[60:63], v19 offset:96
  v_cvt_pk_bf16_f32 v68, v72, v73
  v_cvt_pk_bf16_f32 v69, v74, v75
  v_cvt_pk_bf16_f32 v70, v76, v77
  v_cvt_pk_bf16_f32 v71, v78, v79
  v_alignbit_b32 v24, v25, v24, 16
  v_alignbit_b32 v25, v26, v25, 16
  v_alignbit_b32 v26, v27, v26, 16
  v_lshrrev_b32 v27, 16, v27
  v_add_u32 v19, 0x200, v19
  v_add_u32 v16, s44, v16
  v_add_u32 v17, s44, v17
  s_sub_u32 s44, 0, s44
  v_add_u32 v18, s44, v18
  v_cvt_pk_bf16_f32 v240, v96, v97
  v_cvt_pk_bf16_f32 v241, v98, v99
  v_cvt_pk_bf16_f32 v242, v100, v101
  v_cvt_pk_bf16_f32 v243, v102, v103
  v_cvt_pk_bf16_f32 v244, v104, v105
  v_cvt_pk_bf16_f32 v245, v106, v107
  ds_read_b32 v21, v15 offset:512
  v_cvt_pk_bf16_f32 v246, v108, v109
  v_cvt_pk_bf16_f32 v247, v110, v111
  v_cvt_pk_bf16_f32 v248, v112, v113
  v_cvt_pk_bf16_f32 v249, v114, v115
  v_cvt_pk_bf16_f32 v250, v116, v117
  v_cvt_pk_bf16_f32 v251, v118, v119
  v_cvt_pk_bf16_f32 v252, v120, v121
  v_cvt_pk_bf16_f32 v253, v122, v123
  v_cvt_pk_bf16_f32 v254, v124, v125
  v_cvt_pk_bf16_f32 v255, v126, v127
  s_branch LA_vj4
LA_first5:
  ds_read_b128 v[80:83], v16 offset:0
  ds_read_b128 v[84:87], v17 offset:0
  ds_read_b128 v[88:91], v16 offset:528
  ds_read_b128 v[92:95], v17 offset:528
  ds_write_b16 v18, v24
  s_bitcmp1_b32 s42, 5
  s_waitcnt vmcnt(8)
  s_mov_b64 exec, 1
  ds_inc_u32 v15, v15 offset:512
  s_mov_b64 exec, -1
  ds_read_b128 v[48:51], v16 offset:1056
  ds_read_b128 v[52:55], v17 offset:1056
  ds_read_b128 v[56:59], v16 offset:1584
  ds_read_b128 v[60:63], v17 offset:1584
  s_cbranch_scc1 LA_fepi5
LA_fdone5:
  s_setprio 1
  v_exp_f32 v64, v64
  v_exp_f32 v65, v65
  s_waitcnt lgkmcnt(4)
  v_mfma_f32_32x32x16_bf16 v[96:111], v[80:83], v[192:195], v[128:143]
  v_exp_f32 v66, v66
  v_exp_f32 v67, v67
  v_exp_f32 v68, v68
  v_mfma_f32_32x32x16_bf16 v[96:111], v[84:87], v[196:199], v[96:111]
  v_exp_f32 v69, v69
  v_exp_f32 v70, v70
  v_exp_f32 v71, v71
  v_mfma_f32_32x32x16_bf16 v[112:127], v[88:91], v[200:203], v[144:159]
  v_exp_f32 v72, v72
  v_exp_f32 v73, v73
  v_exp_f32 v74, v74
  v_mfma_f32_32x32x16_bf16 v[112:127], v[92:95], v[204:207], v[112:127]
  v_exp_f32 v75, v75
  v_exp_f32 v76, v76
  v_exp_f32 v77, v77
  v_exp_f32 v78, v78
  v_exp_f32 v79, v79
  v_add_f32 v64, 1.0, v64
  v_add_f32 v65, 1.0, v65
  v_add_f32 v66, 1.0, v66
  s_setprio 2
  v_add_f32 v67, 1.0, v67
  v_add_f32 v68, 1.0, v68
  v_add_f32 v69, 1.0, v69
  v_add_f32 v70, 1.0, v70
  v_add_f32 v71, 1.0, v71
  v_add_f32 v72, 1.0, v72
  v_add_f32 v73, 1.0, v73
  v_add_f32 v74, 1.0, v74
  v_add_f32 v75, 1.0, v75
  v_add_f32 v76, 1.0, v76
  v_add_f32 v77, 1.0, v77
  v_add_f32 v78, 1.0, v78
  v_add_f32 v79, 1.0, v79
  v_cvt_pk_bf16_f32 v224, v96, v97
  v_cvt_pk_bf16_f32 v225, v98, v99
  v_cvt_pk_bf16_f32 v226, v100, v101
  v_cvt_pk_bf16_f32 v227, v102, v103
  v_cvt_pk_bf16_f32 v228, v104, v105
  v_cvt_pk_bf16_f32 v229, v106, v107
  v_cvt_pk_bf16_f32 v230, v108, v109
  v_cvt_pk_bf16_f32 v231, v110, v111
  v_cvt_pk_bf16_f32 v232, v112, v113
  v_cvt_pk_bf16_f32 v233, v114, v115
  v_cvt_pk_bf16_f32 v234, v116, v117
  v_cvt_pk_bf16_f32 v235, v118, v119
  v_cvt_pk_bf16_f32 v236, v120, v121
  v_cvt_pk_bf16_f32 v237, v122, v123
  v_cvt_pk_bf16_f32 v238, v124, v125
  v_cvt_pk_bf16_f32 v239, v126, v127
  v_rcp_f32 v64, v64
  v_rcp_f32 v65, v65
  v_rcp_f32 v66, v66
  v_rcp_f32 v67, v67
  v_rcp_f32 v68, v68
  v_rcp_f32 v69, v69
  v_rcp_f32 v70, v70
  v_rcp_f32 v71, v71
  v_cvt_pk_bf16_f32 v64, v64, v65
  v_cvt_pk_bf16_f32 v65, v66, v67
  v_cvt_pk_bf16_f32 v66, v68, v69
  v_cvt_pk_bf16_f32 v67, v70, v71
  s_waitcnt lgkmcnt(0)
  v_mfma_f32_32x32x16_bf16 v[96:111], v[48:51], v[208:211], v[160:175]
  v_rcp_f32 v72, v72
  v_rcp_f32 v73, v73
  v_rcp_f32 v74, v74
  v_mfma_f32_32x32x16_bf16 v[96:111], v[52:55], v[212:215], v[96:111]
  v_rcp_f32 v75, v75
  v_rcp_f32 v76, v76
  v_rcp_f32 v77, v77
  v_mfma_f32_32x32x16_bf16 v[112:127], v[56:59], v[216:219], v[176:191]
  v_rcp_f32 v78, v78
  v_rcp_f32 v79, v79
  v_mfma_f32_32x32x16_bf16 v[112:127], v[60:63], v[220:223], v[112:127]
  ds_read_b128 v[48:51], v19 offset:0
  ds_read_b128 v[52:55], v19 offset:32
  ds_read_b128 v[56:59], v19 offset:64
  ds_read_b128 v[60:63], v19 offset:96
  v_cvt_pk_bf16_f32 v68, v72, v73
  v_cvt_pk_bf16_f32 v69, v74, v75
  v_cvt_pk_bf16_f32 v70, v76, v77
  v_cvt_pk_bf16_f32 v71, v78, v79
  v_alignbit_b32 v24, v25, v24, 16
  v_alignbit_b32 v25, v26, v25, 16
  v_alignbit_b32 v26, v27, v26, 16
  v_lshrrev_b32 v27, 16, v27
  v_add_u32 v19, 0x200, v19
  v_add_u32 v16, s44, v16
  v_add_u32 v17, s44, v17
  s_sub_u32 s44, 0, s44
  v_add_u32 v18, s44, v18
  v_cvt_pk_bf16_f32 v240, v96, v97
  v_cvt_pk_bf16_f32 v241, v98, v99
  v_cvt_pk_bf16_f32 v242, v100, v101
  v_cvt_pk_bf16_f32 v243, v102, v103
  v_cvt_pk_bf16_f32 v244, v104, v105
  v_cvt_pk_bf16_f32 v245, v106, v107
  ds_read_b32 v21, v15 offset:512
  v_cvt_pk_bf16_f32 v246, v108, v109
  v_cvt_pk_bf16_f32 v247, v110, v111
  v_cvt_pk_bf16_f32 v248, v112, v113
  v_cvt_pk_bf16_f32 v249, v114, v115
  v_cvt_pk_bf16_f32 v250, v116, v117
  v_cvt_pk_bf16_f32 v251, v118, v119
  v_cvt_pk_bf16_f32 v252, v120, v121
  v_cvt_pk_bf16_f32 v253, v122, v123
  v_cvt_pk_bf16_f32 v254, v124, v125
  v_cvt_pk_bf16_f32 v255, v126, v127
  s_branch LA_vj5
LA_first6:
  ds_read_b128 v[80:83], v16 offset:0
  ds_read_b128 v[84:87], v17 offset:0
  ds_read_b128 v[88:91], v16 offset:528
  ds_read_b128 v[92:95], v17 offset:528
  ds_write_b16 v18, v24
  s_bitcmp1_b32 s42, 6
  s_waitcnt vmcnt(8)
  s_mov_b64 exec, 1
  ds_inc_u32 v15, v15 offset:512
  s_mov_b64 exec, -1
  ds_read_b128 v[48:51], v16 offset:1056
  ds_read_b128 v[52:55], v17 offset:1056
  ds_read_b128 v[56:59], v16 offset:1584
  ds_read_b128 v[60:63], v17 offset:1584
  s_cbranch_scc1 LA_fepi6
LA_fdone6:
  s_setprio 1
  v_exp_f32 v64, v64
  v_exp_f32 v65, v65
  s_waitcnt lgkmcnt(4)
  v_mfma_f32_32x32x16_bf16 v[96:111], v[80:83], v[192:195], v[128:143]
  v_exp_f32 v66, v66
  v_exp_f32 v67, v67
  v_exp_f32 v68, v68
  v_mfma_f32_32x32x16_bf16 v[96:111], v[84:87], v[196:199], v[96:111]
  v_exp_f32 v69, v69
  v_exp_f32 v70, v70
  v_exp_f32 v71, v71
  v_mfma_f32_32x32x16_bf16 v[112:127], v[88:91], v[200:203], v[144:159]
  v_exp_f32 v72, v72
  v_exp_f32 v73, v73
  v_exp_f32 v74, v74
  v_mfma_f32_32x32x16_bf16 v[112:127], v[92:95], v[204:207], v[112:127]
  v_exp_f32 v75, v75
  v_exp_f32 v76, v76
  v_exp_f32 v77, v77
  v_exp_f32 v78, v78
  v_exp_f32 v79, v79
  v_add_f32 v64, 1.0, v64
  v_add_f32 v65, 1.0, v65
  v_add_f32 v66, 1.0, v66
  s_setprio 2
  v_add_f32 v67, 1.0, v67
  v_add_f32 v68, 1.0, v68
  v_add_f32 v69, 1.0, v69
  v_add_f32 v70, 1.0, v70
  v_add_f32 v71, 1.0, v71
  v_add_f32 v72, 1.0, v72
  v_add_f32 v73, 1.0, v73
  v_add_f32 v74, 1.0, v74
  v_add_f32 v75, 1.0, v75
  v_add_f32 v76, 1.0, v76
  v_add_f32 v77, 1.0, v77
  v_add_f32 v78, 1.0, v78
  v_add_f32 v79, 1.0, v79
  v_cvt_pk_bf16_f32 v224, v96, v97
  v_cvt_pk_bf16_f32 v225, v98, v99
  v_cvt_pk_bf16_f32 v226, v100, v101
  v_cvt_pk_bf16_f32 v227, v102, v103
  v_cvt_pk_bf16_f32 v228, v104, v105
  v_cvt_pk_bf16_f32 v229, v106, v107
  v_cvt_pk_bf16_f32 v230, v108, v109
  v_cvt_pk_bf16_f32 v231, v110, v111
  v_cvt_pk_bf16_f32 v232, v112, v113
  v_cvt_pk_bf16_f32 v233, v114, v115
  v_cvt_pk_bf16_f32 v234, v116, v117
  v_cvt_pk_bf16_f32 v235, v118, v119
  v_cvt_pk_bf16_f32 v236, v120, v121
  v_cvt_pk_bf16_f32 v237, v122, v123
  v_cvt_pk_bf16_f32 v238, v124, v125
  v_cvt_pk_bf16_f32 v239, v126, v127
  v_rcp_f32 v64, v64
  v_rcp_f32 v65, v65
  v_rcp_f32 v66, v66
  v_rcp_f32 v67, v67
  v_rcp_f32 v68, v68
  v_rcp_f32 v69, v69
  v_rcp_f32 v70, v70
  v_rcp_f32 v71, v71
  v_cvt_pk_bf16_f32 v64, v64, v65
  v_cvt_pk_bf16_f32 v65, v66, v67
  v_cvt_pk_bf16_f32 v66, v68, v69
  v_cvt_pk_bf16_f32 v67, v70, v71
  s_waitcnt lgkmcnt(0)
  v_mfma_f32_32x32x16_bf16 v[96:111], v[48:51], v[208:211], v[160:175]
  v_rcp_f32 v72, v72
  v_rcp_f32 v73, v73
  v_rcp_f32 v74, v74
  v_mfma_f32_32x32x16_bf16 v[96:111], v[52:55], v[212:215], v[96:111]
  v_rcp_f32 v75, v75
  v_rcp_f32 v76, v76
  v_rcp_f32 v77, v77
  v_mfma_f32_32x32x16_bf16 v[112:127], v[56:59], v[216:219], v[176:191]
  v_rcp_f32 v78, v78
  v_rcp_f32 v79, v79
  v_mfma_f32_32x32x16_bf16 v[112:127], v[60:63], v[220:223], v[112:127]
  ds_read_b128 v[48:51], v19 offset:0
  ds_read_b128 v[52:55], v19 offset:32
  ds_read_b128 v[56:59], v19 offset:64
  ds_read_b128 v[60:63], v19 offset:96
  v_cvt_pk_bf16_f32 v68, v72, v73
  v_cvt_pk_bf16_f32 v69, v74, v75
  v_cvt_pk_bf16_f32 v70, v76, v77
  v_cvt_pk_bf16_f32 v71, v78, v79
  v_alignbit_b32 v24, v25, v24, 16
  v_alignbit_b32 v25, v26, v25, 16
  v_alignbit_b32 v26, v27, v26, 16
  v_lshrrev_b32 v27, 16, v27
  v_add_u32 v19, 0x200, v19
  v_add_u32 v16, s44, v16
  v_add_u32 v17, s44, v17
  s_sub_u32 s44, 0, s44
  v_add_u32 v18, s44, v18
  v_cvt_pk_bf16_f32 v240, v96, v97
  v_cvt_pk_bf16_f32 v241, v98, v99
  v_cvt_pk_bf16_f32 v242, v100, v101
  v_cvt_pk_bf16_f32 v243, v102, v103
  v_cvt_pk_bf16_f32 v244, v104, v105
  v_cvt_pk_bf16_f32 v245, v106, v107
  ds_read_b32 v21, v15 offset:512
  v_cvt_pk_bf16_f32 v246, v108, v109
  v_cvt_pk_bf16_f32 v247, v110, v111
  v_cvt_pk_bf16_f32 v248, v112, v113
  v_cvt_pk_bf16_f32 v249, v114, v115
  v_cvt_pk_bf16_f32 v250, v116, v117
  v_cvt_pk_bf16_f32 v251, v118, v119
  v_cvt_pk_bf16_f32 v252, v120, v121
  v_cvt_pk_bf16_f32 v253, v122, v123
  v_cvt_pk_bf16_f32 v254, v124, v125
  v_cvt_pk_bf16_f32 v255, v126, v127
  s_branch LA_vj6
LA_first7:
  ds_read_b128 v[80:83], v16 offset:0
  ds_read_b128 v[84:87], v17 offset:0
  ds_read_b128 v[88:91], v16 offset:528
  ds_read_b128 v[92:95], v17 offset:528
  ds_write_b16 v18, v24
  s_bitcmp1_b32 s42, 7
  s_waitcnt vmcnt(8)
  s_mov_b64 exec, 1
  ds_inc_u32 v15, v15 offset:512
  s_mov_b64 exec, -1
  ds_read_b128 v[48:51], v16 offset:1056
  ds_read_b128 v[52:55], v17 offset:1056
  ds_read_b128 v[56:59], v16 offset:1584
  ds_read_b128 v[60:63], v17 offset:1584
  s_cbranch_scc1 LA_fepi7
LA_fdone7:
  s_setprio 1
  v_exp_f32 v64, v64
  v_exp_f32 v65, v65
  s_waitcnt lgkmcnt(4)
  v_mfma_f32_32x32x16_bf16 v[96:111], v[80:83], v[192:195], v[128:143]
  v_exp_f32 v66, v66
  v_exp_f32 v67, v67
  v_exp_f32 v68, v68
  v_mfma_f32_32x32x16_bf16 v[96:111], v[84:87], v[196:199], v[96:111]
  v_exp_f32 v69, v69
  v_exp_f32 v70, v70
  v_exp_f32 v71, v71
  v_mfma_f32_32x32x16_bf16 v[112:127], v[88:91], v[200:203], v[144:159]
  v_exp_f32 v72, v72
  v_exp_f32 v73, v73
  v_exp_f32 v74, v74
  v_mfma_f32_32x32x16_bf16 v[112:127], v[92:95], v[204:207], v[112:127]
  v_exp_f32 v75, v75
  v_exp_f32 v76, v76
  v_exp_f32 v77, v77
  v_exp_f32 v78, v78
  v_exp_f32 v79, v79
  v_add_f32 v64, 1.0, v64
  v_add_f32 v65, 1.0, v65
  v_add_f32 v66, 1.0, v66
  s_setprio 2
  v_add_f32 v67, 1.0, v67
  v_add_f32 v68, 1.0, v68
  v_add_f32 v69, 1.0, v69
  v_add_f32 v70, 1.0, v70
  v_add_f32 v71, 1.0, v71
  v_add_f32 v72, 1.0, v72
  v_add_f32 v73, 1.0, v73
  v_add_f32 v74, 1.0, v74
  v_add_f32 v75, 1.0, v75
  v_add_f32 v76, 1.0, v76
  v_add_f32 v77, 1.0, v77
  v_add_f32 v78, 1.0, v78
  v_add_f32 v79, 1.0, v79
  v_cvt_pk_bf16_f32 v224, v96, v97
  v_cvt_pk_bf16_f32 v225, v98, v99
  v_cvt_pk_bf16_f32 v226, v100, v101
  v_cvt_pk_bf16_f32 v227, v102, v103
  v_cvt_pk_bf16_f32 v228, v104, v105
  v_cvt_pk_bf16_f32 v229, v106, v107
  v_cvt_pk_bf16_f32 v230, v108, v109
  v_cvt_pk_bf16_f32 v231, v110, v111
  v_cvt_pk_bf16_f32 v232, v112, v113
  v_cvt_pk_bf16_f32 v233, v114, v115
  v_cvt_pk_bf16_f32 v234, v116, v117
  v_cvt_pk_bf16_f32 v235, v118, v119
  v_cvt_pk_bf16_f32 v236, v120, v121
  v_cvt_pk_bf16_f32 v237, v122, v123
  v_cvt_pk_bf16_f32 v238, v124, v125
  v_cvt_pk_bf16_f32 v239, v126, v127
  v_rcp_f32 v64, v64
  v_rcp_f32 v65, v65
  v_rcp_f32 v66, v66
  v_rcp_f32 v67, v67
  v_rcp_f32 v68, v68
  v_rcp_f32 v69, v69
  v_rcp_f32 v70, v70
  v_rcp_f32 v71, v71
  v_cvt_pk_bf16_f32 v64, v64, v65
  v_cvt_pk_bf16_f32 v65, v66, v67
  v_cvt_pk_bf16_f32 v66, v68, v69
  v_cvt_pk_bf16_f32 v67, v70, v71
  s_waitcnt lgkmcnt(0)
  v_mfma_f32_32x32x16_bf16 v[96:111], v[48:51], v[208:211], v[160:175]
  v_rcp_f32 v72, v72
  v_rcp_f32 v73, v73
  v_rcp_f32 v74, v74
  v_mfma_f32_32x32x16_bf16 v[96:111], v[52:55], v[212:215], v[96:111]
  v_rcp_f32 v75, v75
  v_rcp_f32 v76, v76
  v_rcp_f32 v77, v77
  v_mfma_f32_32x32x16_bf16 v[112:127], v[56:59], v[216:219], v[176:191]
  v_rcp_f32 v78, v78
  v_rcp_f32 v79, v79
  v_mfma_f32_32x32x16_bf16 v[112:127], v[60:63], v[220:223], v[112:127]
  ds_read_b128 v[48:51], v19 offset:0
  ds_read_b128 v[52:55], v19 offset:32
  ds_read_b128 v[56:59], v19 offset:64
  ds_read_b128 v[60:63], v19 offset:96
  v_cvt_pk_bf16_f32 v68, v72, v73
  v_cvt_pk_bf16_f32 v69, v74, v75
  v_cvt_pk_bf16_f32 v70, v76, v77
  v_cvt_pk_bf16_f32 v71, v78, v79
  v_alignbit_b32 v24, v25, v24, 16
  v_alignbit_b32 v25, v26, v25, 16
  v_alignbit_b32 v26, v27, v26, 16
  v_lshrrev_b32 v27, 16, v27
  v_add_u32 v19, 0x200, v19
  v_add_u32 v16, s44, v16
  v_add_u32 v17, s44, v17
  s_sub_u32 s44, 0, s44
  v_add_u32 v18, s44, v18
  v_cvt_pk_bf16_f32 v240, v96, v97
  v_cvt_pk_bf16_f32 v241, v98, v99
  v_cvt_pk_bf16_f32 v242, v100, v101
  v_cvt_pk_bf16_f32 v243, v102, v103
  v_cvt_pk_bf16_f32 v244, v104, v105
  v_cvt_pk_bf16_f32 v245, v106, v107
  ds_read_b32 v21, v15 offset:512
  v_cvt_pk_bf16_f32 v246, v108, v109
  v_cvt_pk_bf16_f32 v247, v110, v111
  v_cvt_pk_bf16_f32 v248, v112, v113
  v_cvt_pk_bf16_f32 v249, v114, v115
  v_cvt_pk_bf16_f32 v250, v116, v117
  v_cvt_pk_bf16_f32 v251, v118, v119
  v_cvt_pk_bf16_f32 v252, v120, v121
  v_cvt_pk_bf16_f32 v253, v122, v123
  v_cvt_pk_bf16_f32 v254, v124, v125
  v_cvt_pk_bf16_f32 v255, v126, v127
  s_branch LA_vj7
LA_epi0:
  v_add_f32 v96, v32, v33
  v_add_f32 v97, v34, v35
  v_add_f32 v98, v36, v37
  v_add_f32 v99, v38, v39
  v_add_f32 v96, v96, v97
  v_add_f32 v98, v98, v99
  v_mov_b32 v32, 0
  v_mov_b32 v33, 0
  v_mov_b32 v34, 0
  v_mov_b32 v35, 0
  v_mov_b32 v36, 0
  v_mov_b32 v37, 0
  v_mov_b32 v38, 0
  v_mov_b32 v39, 0
  v_cndmask_b32 v96, v96, v98, s[46:47]
  v_cvt_pk_bf16_f32 v96, v96, v96
  buffer_store_short v96, v20, s[12:15], 0 offen
  s_add_u32 s12, s12, 256
  s_addc_u32 s13, s13, 0
  s_branch LA_done0
LA_fepi0:
  v_add_f32 v96, v32, v33
  v_add_f32 v97, v34, v35
  v_add_f32 v98, v36, v37
  v_add_f32 v99, v38, v39
  v_add_f32 v96, v96, v97
  v_add_f32 v98, v98, v99
  v_mov_b32 v32, 0
  v_mov_b32 v33, 0
  v_mov_b32 v34, 0
  v_mov_b32 v35, 0
  v_mov_b32 v36, 0
  v_mov_b32 v37, 0
  v_mov_b32 v38, 0
  v_mov_b32 v39, 0
  v_cndmask_b32 v96, v96, v98, s[46:47]
  v_cvt_pk_bf16_f32 v96, v96, v96
  buffer_store_short v96, v20, s[12:15], 0 offen
  s_add_u32 s12, s12, 256
  s_addc_u32 s13, s13, 0
  s_branch LA_fdone0
LA_epi1:
  v_add_f32 v96, v32, v33
  v_add_f32 v97, v34, v35
  v_add_f32 v98, v36, v37
  v_add_f32 v99, v38, v39
  v_add_f32 v96, v96, v97
  v_add_f32 v98, v98, v99
  v_mov_b32 v32, 0
  v_mov_b32 v33, 0
  v_mov_b32 v34, 0
  v_mov_b32 v35, 0
  v_mov_b32 v36, 0
  v_mov_b32 v37, 0
  v_mov_b32 v38, 0
  v_mov_b32 v39, 0
  v_cndmask_b32 v96, v96, v98, s[46:47]
  v_cvt_pk_bf16_f32 v96, v96, v96
  buffer_store_short v96, v20, s[12:15], 0 offen
  s_add_u32 s12, s12, 256
  s_addc_u32 s13, s13, 0
  s_branch LA_done1
LA_fepi1:
  v_add_f32 v96, v32, v33
  v_add_f32 v97, v34, v35
  v_add_f32 v98, v36, v37
  v_add_f32 v99, v38, v39
  v_add_f32 v96, v96, v97
  v_add_f32 v98, v98, v99
  v_mov_b32 v32, 0
  v_mov_b32 v33, 0
  v_mov_b32 v34, 0
  v_mov_b32 v35, 0
  v_mov_b32 v36, 0
  v_mov_b32 v37, 0
  v_mov_b32 v38, 0
  v_mov_b32 v39, 0
  v_cndmask_b32 v96, v96, v98, s[46:47]
  v_cvt_pk_bf16_f32 v96, v96, v96
  buffer_store_short v96, v20, s[12:15], 0 offen
  s_add_u32 s12, s12, 256
  s_addc_u32 s13, s13, 0
  s_branch LA_fdone1
LA_epi2:
  v_add_f32 v96, v32, v33
  v_add_f32 v97, v34, v35
  v_add_f32 v98, v36, v37
  v_add_f32 v99, v38, v39
  v_add_f32 v96, v96, v97
  v_add_f32 v98, v98, v99
  v_mov_b32 v32, 0
  v_mov_b32 v33, 0
  v_mov_b32 v34, 0
  v_mov_b32 v35, 0
  v_mov_b32 v36, 0
  v_mov_b32 v37, 0
  v_mov_b32 v38, 0
  v_mov_b32 v39, 0
  v_cndmask_b32 v96, v96, v98, s[46:47]
  v_cvt_pk_bf16_f32 v96, v96, v96
  buffer_store_short v96, v20, s[12:15], 0 offen
  s_add_u32 s12, s12, 256
  s_addc_u32 s13, s13, 0
  s_branch LA_done2
LA_fepi2:
  v_add_f32 v96, v32, v33
  v_add_f32 v97, v34, v35
  v_add_f32 v98, v36, v37
  v_add_f32 v99, v38, v39
  v_add_f32 v96, v96, v97
  v_add_f32 v98, v98, v99
  v_mov_b32 v32, 0
  v_mov_b32 v33, 0
  v_mov_b32 v34, 0
  v_mov_b32 v35, 0
  v_mov_b32 v36, 0
  v_mov_b32 v37, 0
  v_mov_b32 v38, 0
  v_mov_b32 v39, 0
  v_cndmask_b32 v96, v96, v98, s[46:47]
  v_cvt_pk_bf16_f32 v96, v96, v96
  buffer_store_short v96, v20, s[12:15], 0 offen
  s_add_u32 s12, s12, 256
  s_addc_u32 s13, s13, 0
  s_branch LA_fdone2
LA_epi3:
  v_add_f32 v96, v32, v33
  v_add_f32 v97, v34, v35
  v_add_f32 v98, v36, v37
  v_add_f32 v99, v38, v39
  v_add_f32 v96, v96, v97
  v_add_f32 v98, v98, v99
  v_mov_b32 v32, 0
  v_mov_b32 v33, 0
  v_mov_b32 v34, 0
  v_mov_b32 v35, 0
  v_mov_b32 v36, 0
  v_mov_b32 v37, 0
  v_mov_b32 v38, 0
  v_mov_b32 v39, 0
  v_cndmask_b32 v96, v96, v98, s[46:47]
  v_cvt_pk_bf16_f32 v96, v96, v96
  buffer_store_short v96, v20, s[12:15], 0 offen
  s_add_u32 s12, s12, 256
  s_addc_u32 s13, s13, 0
  s_branch LA_done3
LA_fepi3:
  v_add_f32 v96, v32, v33
  v_add_f32 v97, v34, v35
  v_add_f32 v98, v36, v37
  v_add_f32 v99, v38, v39
  v_add_f32 v96, v96, v97
  v_add_f32 v98, v98, v99
  v_mov_b32 v32, 0
  v_mov_b32 v33, 0
  v_mov_b32 v34, 0
  v_mov_b32 v35, 0
  v_mov_b32 v36, 0
  v_mov_b32 v37, 0
  v_mov_b32 v38, 0
  v_mov_b32 v39, 0
  v_cndmask_b32 v96, v96, v98, s[46:47]
  v_cvt_pk_bf16_f32 v96, v96, v96
  buffer_store_short v96, v20, s[12:15], 0 offen
  s_add_u32 s12, s12, 256
  s_addc_u32 s13, s13, 0
  s_branch LA_fdone3
LA_epi4:
  v_add_f32 v96, v32, v33
  v_add_f32 v97, v34, v35
  v_add_f32 v98, v36, v37
  v_add_f32 v99, v38, v39
  v_add_f32 v96, v96, v97
  v_add_f32 v98, v98, v99
  v_mov_b32 v32, 0
  v_mov_b32 v33, 0
  v_mov_b32 v34, 0
  v_mov_b32 v35, 0
  v_mov_b32 v36, 0
  v_mov_b32 v37, 0
  v_mov_b32 v38, 0
  v_mov_b32 v39, 0
  v_cndmask_b32 v96, v96, v98, s[46:47]
  v_cvt_pk_bf16_f32 v96, v96, v96
  buffer_store_short v96, v20, s[12:15], 0 offen
  s_add_u32 s12, s12, 256
  s_addc_u32 s13, s13, 0
  s_branch LA_done4
LA_fepi4:
  v_add_f32 v96, v32, v33
  v_add_f32 v97, v34, v35
  v_add_f32 v98, v36, v37
  v_add_f32 v99, v38, v39
  v_add_f32 v96, v96, v97
  v_add_f32 v98, v98, v99
  v_mov_b32 v32, 0
  v_mov_b32 v33, 0
  v_mov_b32 v34, 0
  v_mov_b32 v35, 0
  v_mov_b32 v36, 0
  v_mov_b32 v37, 0
  v_mov_b32 v38, 0
  v_mov_b32 v39, 0
  v_cndmask_b32 v96, v96, v98, s[46:47]
  v_cvt_pk_bf16_f32 v96, v96, v96
  buffer_store_short v96, v20, s[12:15], 0 offen
  s_add_u32 s12, s12, 256
  s_addc_u32 s13, s13, 0
  s_branch LA_fdone4
LA_epi5:
  v_add_f32 v96, v32, v33
  v_add_f32 v97, v34, v35
  v_add_f32 v98, v36, v37
  v_add_f32 v99, v38, v39
  v_add_f32 v96, v96, v97
  v_add_f32 v98, v98, v99
  v_mov_b32 v32, 0
  v_mov_b32 v33, 0
  v_mov_b32 v34, 0
  v_mov_b32 v35, 0
  v_mov_b32 v36, 0
  v_mov_b32 v37, 0
  v_mov_b32 v38, 0
  v_mov_b32 v39, 0
  v_cndmask_b32 v96, v96, v98, s[46:47]
  v_cvt_pk_bf16_f32 v96, v96, v96
  buffer_store_short v96, v20, s[12:15], 0 offen
  s_add_u32 s12, s12, 256
  s_addc_u32 s13, s13, 0
  s_branch LA_done5
LA_fepi5:
  v_add_f32 v96, v32, v33
  v_add_f32 v97, v34, v35
  v_add_f32 v98, v36, v37
  v_add_f32 v99, v38, v39
  v_add_f32 v96, v96, v97
  v_add_f32 v98, v98, v99
  v_mov_b32 v32, 0
  v_mov_b32 v33, 0
  v_mov_b32 v34, 0
  v_mov_b32 v35, 0
  v_mov_b32 v36, 0
  v_mov_b32 v37, 0
  v_mov_b32 v38, 0
  v_mov_b32 v39, 0
  v_cndmask_b32 v96, v96, v98, s[46:47]
  v_cvt_pk_bf16_f32 v96, v96, v96
  buffer_store_short v96, v20, s[12:15], 0 offen
  s_add_u32 s12, s12, 256
  s_addc_u32 s13, s13, 0
  s_branch LA_fdone5
LA_epi6:
  v_add_f32 v96, v32, v33
  v_add_f32 v97, v34, v35
  v_add_f32 v98, v36, v37
  v_add_f32 v99, v38, v39
  v_add_f32 v96, v96, v97
  v_add_f32 v98, v98, v99
  v_mov_b32 v32, 0
  v_mov_b32 v33, 0
  v_mov_b32 v34, 0
  v_mov_b32 v35, 0
  v_mov_b32 v36, 0
  v_mov_b32 v37, 0
  v_mov_b32 v38, 0
  v_mov_b32 v39, 0
  v_cndmask_b32 v96, v96, v98, s[46:47]
  v_cvt_pk_bf16_f32 v96, v96, v96
  buffer_store_short v96, v20, s[12:15], 0 offen
  s_add_u32 s12, s12, 256
  s_addc_u32 s13, s13, 0
  s_branch LA_done6
LA_fepi6:
  v_add_f32 v96, v32, v33
  v_add_f32 v97, v34, v35
  v_add_f32 v98, v36, v37
  v_add_f32 v99, v38, v39
  v_add_f32 v96, v96, v97
  v_add_f32 v98, v98, v99
  v_mov_b32 v32, 0
  v_mov_b32 v33, 0
  v_mov_b32 v34, 0
  v_mov_b32 v35, 0
  v_mov_b32 v36, 0
  v_mov_b32 v37, 0
  v_mov_b32 v38, 0
  v_mov_b32 v39, 0
  v_cndmask_b32 v96, v96, v98, s[46:47]
  v_cvt_pk_bf16_f32 v96, v96, v96
  buffer_store_short v96, v20, s[12:15], 0 offen
  s_add_u32 s12, s12, 256
  s_addc_u32 s13, s13, 0
  s_branch LA_fdone6
LA_epi7:
  v_add_f32 v96, v32, v33
  v_add_f32 v97, v34, v35
  v_add_f32 v98, v36, v37
  v_add_f32 v99, v38, v39
  v_add_f32 v96, v96, v97
  v_add_f32 v98, v98, v99
  v_mov_b32 v32, 0
  v_mov_b32 v33, 0
  v_mov_b32 v34, 0
  v_mov_b32 v35, 0
  v_mov_b32 v36, 0
  v_mov_b32 v37, 0
  v_mov_b32 v38, 0
  v_mov_b32 v39, 0
  v_cndmask_b32 v96, v96, v98, s[46:47]
  v_cvt_pk_bf16_f32 v96, v96, v96
  buffer_store_short v96, v20, s[12:15], 0 offen
  s_add_u32 s12, s12, 256
  s_addc_u32 s13, s13, 0
  s_branch LA_done7
LA_fepi7:
  v_add_f32 v96, v32, v33
  v_add_f32 v97, v34, v35
  v_add_f32 v98, v36, v37
  v_add_f32 v99, v38, v39
  v_add_f32 v96, v96, v97
  v_add_f32 v98, v98, v99
  v_mov_b32 v32, 0
  v_mov_b32 v33, 0
  v_mov_b32 v34, 0
  v_mov_b32 v35, 0
  v_mov_b32 v36, 0
  v_mov_b32 v37, 0
  v_mov_b32 v38, 0
  v_mov_b32 v39, 0
  v_cndmask_b32 v96, v96, v98, s[46:47]
  v_cvt_pk_bf16_f32 v96, v96, v96
  buffer_store_short v96, v20, s[12:15], 0 offen
  s_add_u32 s12, s12, 256
  s_addc_u32 s13, s13, 0
  s_branch LA_fdone7
LA_slow0:
  s_cmp_eq_u32 s93, -1
  s_cbranch_scc1 LA_stub0
LA_spin0:
  ds_read_b32 v21, v15 offset:512
  s_waitcnt lgkmcnt(0)
  v_readfirstlane_b32 s55, v21
s_nop 0
  s_cmp_ge_u32 s55, s93
  s_cbranch_scc0 LA_spin0
  s_branch LA_b1
LA_slow1:
  s_cmp_eq_u32 s93, -1
  s_cbranch_scc1 LA_stub1
LA_spin1:
  ds_read_b32 v21, v15 offset:512
  s_waitcnt lgkmcnt(0)
  v_readfirstlane_b32 s55, v21
s_nop 0
  s_cmp_ge_u32 s55, s93
  s_cbranch_scc0 LA_spin1
  s_branch LA_b2
LA_slow2:
  s_cmp_eq_u32 s93, -1
  s_cbranch_scc1 LA_stub2
LA_spin2:
  ds_read_b32 v21, v15 offset:512
  s_waitcnt lgkmcnt(0)
  v_readfirstlane_b32 s55, v21
s_nop 0
  s_cmp_ge_u32 s55, s93
  s_cbranch_scc0 LA_spin2
  s_branch LA_b3
LA_slow3:
  s_cmp_eq_u32 s93, -1
  s_cbranch_scc1 LA_stub3
LA_spin3:
  ds_read_b32 v21, v15 offset:512
  s_waitcnt lgkmcnt(0)
  v_readfirstlane_b32 s55, v21
s_nop 0
  s_cmp_ge_u32 s55, s93
  s_cbranch_scc0 LA_spin3
  s_branch LA_b4
LA_slow4:
  s_cmp_eq_u32 s93, -1
  s_cbranch_scc1 LA_stub4
LA_spin4:
  ds_read_b32 v21, v15 offset:512
  s_waitcnt lgkmcnt(0)
  v_readfirstlane_b32 s55, v21
s_nop 0
  s_cmp_ge_u32 s55, s93
  s_cbranch_scc0 LA_spin4
  s_branch LA_b5
LA_slow5:
  s_cmp_eq_u32 s93, -1
  s_cbranch_scc1 LA_stub5
LA_spin5:
  ds_read_b32 v21, v15 offset:512
  s_waitcnt lgkmcnt(0)
  v_readfirstlane_b32 s55, v21
s_nop 0
  s_cmp_ge_u32 s55, s93
  s_cbranch_scc0 LA_spin5
  s_branch LA_b6
LA_slow6:
  s_cmp_eq_u32 s93, -1
  s_cbranch_scc1 LA_stub6
LA_spin6:
  ds_read_b32 v21, v15 offset:512
  s_waitcnt lgkmcnt(0)
  v_readfirstlane_b32 s55, v21
s_nop 0
  s_cmp_ge_u32 s55, s93
  s_cbranch_scc0 LA_spin6
  s_branch LA_b7
LA_slow7:
  s_cmp_eq_u32 s93, -1
  s_cbranch_scc1 LA_stub7
LA_spin7:
  ds_read_b32 v21, v15 offset:512
  s_waitcnt lgkmcnt(0)
  v_readfirstlane_b32 s55, v21
s_nop 0
  s_cmp_ge_u32 s55, s93
  s_cbranch_scc0 LA_spin7
  s_branch LA_b0
LA_stub0:
  s_mov_b32 s50, 57344
  s_mov_b32 s51, 0
  s_mov_b32 s53, 256
  s_mov_b32 s54, 0
  s_lshr_b64 s[42:43], s[42:43], 1
  s_branch L_tail
LA_stub1:
  s_mov_b32 s50, 0
  s_mov_b32 s51, 8192
  s_mov_b32 s53, 0
  s_mov_b32 s54, 256
  s_lshr_b64 s[42:43], s[42:43], 2
  s_branch L_tail
LA_stub2:
  s_mov_b32 s50, 8192
  s_mov_b32 s51, 16384
  s_mov_b32 s53, 256
  s_mov_b32 s54, 0
  s_lshr_b64 s[42:43], s[42:43], 3
  s_branch L_tail
LA_stub3:
  s_mov_b32 s50, 16384
  s_mov_b32 s51, 24576
  s_mov_b32 s53, 0
  s_mov_b32 s54, 256
  s_lshr_b64 s[42:43], s[42:43], 4
  s_branch L_tail
LA_stub4:
  s_mov_b32 s50, 24576
  s_mov_b32 s51, 32768
  s_mov_b32 s53, 256
  s_mov_b32 s54, 0
  s_lshr_b64 s[42:43], s[42:43], 5
  s_branch L_tail
LA_stub5:
  s_mov_b32 s50, 32768
  s_mov_b32 s51, 40960
  s_mov_b32 s53, 0
  s_mov_b32 s54, 256
  s_lshr_b64 s[42:43], s[42:43], 6
  s_branch L_tail
LA_stub6:
  s_mov_b32 s50, 40960
  s_mov_b32 s51, 49152
  s_mov_b32 s53, 256
  s_mov_b32 s54, 0
  s_lshr_b64 s[42:43], s[42:43], 7
  s_branch L_tail
LA_stub7:
  s_mov_b32 s50, 49152
  s_mov_b32 s51, 57344
  s_mov_b32 s53, 0
  s_mov_b32 s54, 256
  s_branch L_tail
L_tail:
  s_mov_b32 s93, s92
  s_setprio 2
L_tspin0:
  ds_read_b32 v21, v15 offset:512
  s_waitcnt lgkmcnt(0)
  v_readfirstlane_b32 s55, v21
s_nop 0
  s_cmp_ge_u32 s55, s93
  s_cbranch_scc0 L_tspin0
  v_mfma_f32_16x16x32_bf16 v[28:31], v[40:43], v[64:67], v[22:25]
  v_mfma_f32_16x16x32_bf16 v[28:31], v[44:47], v[68:71], v[28:31]
  v_add_u32 v120, s54, v14
s_nop 6
  v_mul_f32 v28, v28, v12
  v_mul_f32 v29, v29, v13
  v_cvt_pk_bf16_f32 v28, v28, v29
  ds_write_b32 v120, v28 offset:0
  v_add_u32 v122, s53, v15
  v_add_u32 v116, s50, v4
  v_add_u32 v117, s50, v5
  v_add_u32 v118, s50, v6
  v_add_u32 v119, s50, v7
  ds_read_b64_tr_b16 v[80:81], v116
  ds_read_b64_tr_b16 v[84:85], v117
  ds_read_b64_tr_b16 v[82:83], v118
  ds_read_b64_tr_b16 v[86:87], v119
  ds_read_b128 v[88:91], v122
  s_waitcnt lgkmcnt(0)
  v_mfma_f32_16x16x32_bf16 v[32:35], v[88:91], v[80:83], v[32:35]
  v_mfma_f32_16x16x32_bf16 v[36:39], v[88:91], v[84:87], v[36:39]
  s_bitcmp1_b32 s42, 0
  s_cbranch_scc0 L_t1
s_nop 4
  v_add_f32 v96, v32, v33
  v_add_f32 v97, v34, v35
  v_add_f32 v98, v36, v37
  v_add_f32 v99, v38, v39
  v_add_f32 v96, v96, v97
  v_add_f32 v98, v98, v99
  v_mov_b32 v32, 0
  v_mov_b32 v33, 0
  v_mov_b32 v34, 0
  v_mov_b32 v35, 0
  v_mov_b32 v36, 0
  v_mov_b32 v37, 0
  v_mov_b32 v38, 0
  v_mov_b32 v39, 0
  v_cndmask_b32 v96, v96, v98, s[46:47]
  v_cvt_pk_bf16_f32 v96, v96, v96
  buffer_store_short v96, v20, s[12:15], 0 offen
  s_add_u32 s12, s12, 256
  s_addc_u32 s13, s13, 0
L_t1:
  s_add_u32 s93, s93, 4
  s_mov_b64 exec, 1
  ds_inc_u32 v15, v15 offset:512
  s_mov_b64 exec, -1
L_tspin:
  ds_read_b32 v21, v15 offset:512
  s_waitcnt lgkmcnt(0)
  v_readfirstlane_b32 s55, v21
s_nop 0
  s_cmp_ge_u32 s55, s93
  s_cbranch_scc0 L_tspin
  v_add_u32 v122, s54, v15
  v_add_u32 v116, s51, v4
  v_add_u32 v117, s51, v5
  v_add_u32 v118, s51, v6
  v_add_u32 v119, s51, v7
  ds_read_b64_tr_b16 v[80:81], v116
  ds_read_b64_tr_b16 v[84:85], v117
  ds_read_b64_tr_b16 v[82:83], v118
  ds_read_b64_tr_b16 v[86:87], v119
  ds_read_b128 v[88:91], v122
  s_waitcnt lgkmcnt(0)
  v_mfma_f32_16x16x32_bf16 v[32:35], v[88:91], v[80:83], v[32:35]
  v_mfma_f32_16x16x32_bf16 v[36:39], v[88:91], v[84:87], v[36:39]
s_nop 6
  v_add_f32 v96, v32, v33
  v_add_f32 v97, v34, v35
  v_add_f32 v98, v36, v37
  v_add_f32 v99, v38, v39
  v_add_f32 v96, v96, v97
  v_add_f32 v98, v98, v99
  v_mov_b32 v32, 0
  v_mov_b32 v33, 0
  v_mov_b32 v34, 0
  v_mov_b32 v35, 0
  v_mov_b32 v36, 0
  v_mov_b32 v37, 0
  v_mov_b32 v38, 0
  v_mov_b32 v39, 0
  v_cndmask_b32 v96, v96, v98, s[46:47]
  v_cvt_pk_bf16_f32 v96, v96, v96
  buffer_store_short v96, v20, s[12:15], 0 offen
  s_add_u32 s12, s12, 256
  s_addc_u32 s13, s13, 0
  s_waitcnt vmcnt(0)
L_end:
  s_endpgm
.section .rodata,"a"
.p2align 6
.amdhsa_kernel standalone__sequential_behavior_din__recsys_kernel
  .amdhsa_next_free_vgpr 256
  .amdhsa_next_free_sgpr 102
  .amdhsa_accum_offset 256
  .amdhsa_group_segment_fixed_size 0
  .amdhsa_kernarg_size 80
  .amdhsa_user_sgpr_count 2
  .amdhsa_user_sgpr_kernarg_segment_ptr 1
  .amdhsa_system_sgpr_workgroup_id_x 1
.end_amdhsa_kernel
```
